```python
import torch

def _softmax(x, axis=-1):
    return torch.softmax(x, dim=axis)
def _gelu(x):
    return torch.nn.functional.gelu(x, approximate="tanh")
def _silu(x):
    return torch.nn.functional.silu(x)
def _sigmoid(x):
    return torch.sigmoid(x)
def _layernorm(x, axis=-1, eps=1e-5):
    m = x.mean(dim=axis, keepdim=True)
    v = x.var(dim=axis, keepdim=True, unbiased=False)
    return (x - m) / torch.sqrt(v + eps)
def _scatter_add(tgt, idx, src, axis=0):
    return tgt.clone().index_add_(axis, idx, src)
def _segment_sum(src, seg, n):
    out = torch.zeros((n,) + src.shape[1:], dtype=src.dtype)
    return out.index_add_(0, seg, src)
def _pad(x, pw):
    flat = tuple(v for pair in reversed(pw) for v in pair)
    return torch.nn.functional.pad(x, flat)

kernel_name = 'standalone__groupnorm__prompt'

def setup_inputs():

    _w = (lambda a: (lambda t: t.to(torch.bfloat16) if t.is_floating_point() else t)(torch.as_tensor(a)))
    B = 2
    G = 32
    cpg = max(1, 576 // G)
    C = G * cpg
    H, W = 32, 2048
    return {
        "x": _w(abs((lambda *s: torch.randn(*s, dtype=torch.bfloat16) * 0.05)(B, C, H, W))),
        "g": _w((lambda *s: torch.randn(*s, dtype=torch.bfloat16) * 0.05)(C) + 1.0),
        "b": _w((lambda *s: torch.randn(*s, dtype=torch.bfloat16) * 0.4)(C)),
    }

def reference(x, g, b):
    G = 32
    B, C, H, W = x.shape[0], x.shape[1], x.shape[2], x.shape[3]
    xr = x.reshape(B, G, C // G, H, W)
    mu = xr.mean(axis=(2, 3, 4), keepdims=True)
    var = ((xr - mu) ** 2).mean(axis=(2, 3, 4), keepdims=True)
    xn = (xr - mu) / torch.sqrt(var + 1e-5)
    xn = xn.reshape(B, C, H, W)
    return xn * g[None, :, None, None] + b[None, :, None, None]
```

```asm
; @launch grid=(1024,1,1) block=(256,1,1) lds=33024
.amdgcn_target "amdgcn-amd-amdhsa--gfx950"
.text
.globl standalone__groupnorm__prompt_kernel
.p2align 8
.type standalone__groupnorm__prompt_kernel,@function
standalone__groupnorm__prompt_kernel:
    s_cmp_ge_u32 s2, 1024
    s_cbranch_scc1 L_end
    s_load_dwordx8 s[4:11], s[0:1], 0
    s_load_dwordx2 s[14:15], s[0:1], 40
    s_setprio 2
    v_lshrrev_b32 v3, 6, v0
    v_and_b32 v2, 63, v0
    v_lshlrev_b32 v2, 4, v2
    v_readfirstlane_b32 s24, v3
    v_lshl_add_u32 v1, v3, 12, v2
    v_mov_b32 v6, 0
    s_lshr_b32 s25, s2, 4
    s_and_b32 s26, s2, 15
    s_lshr_b32 s27, s2, 3
    s_lshl_b32 s27, s27, 2
    s_and_b32 s28, s2, 3
    s_add_u32 s27, s27, s28
    s_mul_i32 s3, s27, 294912
    s_and_b32 s58, s27, 3
    s_lshr_b32 s57, s2, 2
    s_and_b32 s57, s57, 1
    s_lshr_b32 s29, s24, 1
    s_lshl_b32 s29, s29, 14
    s_and_b32 s59, s24, 1
    v_add_u32 v0, s29, v2
    s_and_b32 s55, s27, 7
    s_mul_i32 s54, s55, 9
    s_lshr_b32 s54, s54, 2
    s_and_b32 s60, s25, 31
    s_mul_i32 s60, s60, 18
    s_add_u32 s54, s54, s60
    s_lshl_b32 s54, s54, 1
    v_lshrrev_b32 v4, 3, v2
    v_add_u32 v4, s54, v4
    s_mul_i32 s60, s25, 4096
    s_mul_i32 s61, s55, 294912
    s_lshl_b32 s55, s55, 7
    s_waitcnt lgkmcnt(0)
    s_add_u32 s52, s14, s60
    s_addc_u32 s53, s15, 0
    s_load_dword s50, s[52:53], 256
    s_lshr_b32 s60, s2, 8
    s_sub_u32 s60, 3, s60
    s_max_i32 s60, s60, 0
    s_mov_b32 s79, s60
    s_mul_i32 s60, s60, 65536
    s_add_u32 s76, s52, s60
    s_addc_u32 s77, s53, 0
    s_load_dword s78, s[76:77], 256
    s_add_u32 s16, s4, s3
    s_addc_u32 s17, s5, 0
    s_and_b32 s17, s17, 0xffff
    s_mov_b32 s18, 294912
    s_mov_b32 s19, 0x00020000
    s_add_u32 s20, s10, s3
    s_addc_u32 s21, s11, 0
    s_and_b32 s21, s21, 0xffff
    s_mov_b32 s22, 294912
    s_mov_b32 s23, 0x00020000
    s_mov_b32 s37, 0x3f803f80
    s_mov_b32 s38, 0xffff0000
    s_lshr_b32 s13, s20, 12
    s_and_b32 s13, s13, 3
    s_lshr_b32 s51, s16, 12
    s_and_b32 s51, s51, 3
    s_and_b32 s56, s20, 0x1fffff
    s_sub_u32 s56, 0x200000, s56
    s_add_u32 s56, s56, 32767
    s_lshr_b32 s56, s56, 15
    s_and_b32 s12, s16, 0x1fffff
    s_sub_u32 s12, 0x200000, s12
    s_add_u32 s12, s12, 32767
    s_lshr_b32 s12, s12, 15
    s_mov_b32 s39, 4
    s_cmp_ge_u32 s2, 256
    s_cbranch_scc1 L_reader
    s_cmp_lg_u32 s24, 0
    s_cbranch_scc1 L_r0_other
    s_load_dword s40, s[52:53], 65792
    s_load_dword s41, s[52:53], 131328
    s_load_dword s42, s[52:53], 196864
    s_cmp_eq_u32 s57, 0
    s_cselect_b64 s[44:45], s[16:17], s[20:21]
    s_cselect_b32 s60, s51, s13
    s_bitcmp1_b32 s55, 7
    s_cselect_b32 s61, 113246208, 0
    s_add_u32 s44, s44, s61
    s_addc_u32 s45, s45, 0
    s_mov_b32 s46, 294912
    s_mov_b32 s47, 0x00020000
    s_sub_u32 s61, 4, s60
    s_and_b32 s61, s61, 3
    s_lshl_b32 s61, s61, 12
    v_mov_b32 v8, s61
    s_sub_u32 s61, 6, s60
    s_and_b32 s61, s61, 3
    s_lshl_b32 s61, s61, 12
    v_mov_b32 v11, s61
    buffer_load_dword v9, v8, s[44:47], 0 offen sc0 sc1
    buffer_load_dword v12, v11, s[44:47], 0 offen sc0 sc1
    v_mbcnt_lo_u32_b32 v13, -1, 0
    v_and_b32 v10, 3, v13
    v_mul_u32_u24 v10, 65536, v10
    v_lshrrev_b32 v13, 2, v13
    v_lshl_add_u32 v10, v13, 10, v10
    s_lshl_b32 s60, s57, 3
    s_add_u32 s60, s60, s55
    s_add_u32 s60, s60, 1024
    v_add_u32 v10, s60, v10
    s_lshr_b32 s62, s39, 1
    s_and_b32 s62, s62, 1
    s_xor_b32 s62, s62, s57
    s_xor_b32 s63, s62, 1
    s_cmp_eq_u32 s39, 4
    s_cselect_b32 s62, s57, s62
    s_cselect_b32 s63, s57, s63
    s_sub_u32 s65, s59, s13
    s_lshl_b32 s62, s62, 1
    s_add_u32 s66, s62, s65
    s_and_b32 s66, s66, 3
    s_lshl_b32 s66, s66, 12
    s_lshl_b32 s63, s63, 1
    s_add_u32 s67, s63, s65
    s_and_b32 s67, s67, 3
    s_lshl_b32 s67, s67, 12
    s_xor_b32 s65, s59, 1
    s_sub_u32 s65, s65, s13
    s_add_u32 s68, s62, s65
    s_and_b32 s68, s68, 3
    s_lshl_b32 s68, s68, 12
    s_add_u32 s69, s63, s65
    s_and_b32 s69, s69, 3
    s_lshl_b32 s69, s69, 12
    s_mov_b32 s62, s39
    s_and_b32 s62, s62, 1
    s_xor_b32 s62, s62, s57
    s_xor_b32 s63, s62, 1
    s_cmp_eq_u32 s39, 4
    s_cselect_b32 s62, s57, s62
    s_cselect_b32 s63, s57, s63
    s_sub_u32 s65, s59, s51
    s_lshl_b32 s62, s62, 1
    s_add_u32 s70, s62, s65
    s_and_b32 s70, s70, 3
    s_lshl_b32 s70, s70, 12
    s_lshl_b32 s63, s63, 1
    s_add_u32 s71, s63, s65
    s_and_b32 s71, s71, 3
    s_lshl_b32 s71, s71, 12
    s_xor_b32 s65, s59, 1
    s_sub_u32 s65, s65, s51
    s_add_u32 s72, s62, s65
    s_and_b32 s72, s72, 3
    s_lshl_b32 s72, s72, 12
    s_add_u32 s73, s63, s65
    s_and_b32 s73, s73, 3
    s_lshl_b32 s73, s73, 12
    s_cmp_lt_u32 s24, 2
    s_cselect_b32 s74, s66, s70
    s_cselect_b32 s70, s70, s66
    s_mov_b32 s66, s74
    s_cselect_b32 s74, s67, s71
    s_cselect_b32 s71, s71, s67
    s_mov_b32 s67, s74
    s_cselect_b32 s74, s68, s72
    s_cselect_b32 s72, s72, s68
    s_mov_b32 s68, s74
    s_cselect_b32 s74, s69, s73
    s_cselect_b32 s73, s73, s69
    s_mov_b32 s69, s74
    s_cselect_b32 s74, s56, s12
    s_cselect_b32 s75, s12, s56
    s_cmp_gt_u32 s74, 0
    s_cselect_b32 s28, s66, s67
    s_cmp_gt_u32 s75, 1
    s_cselect_b32 s29, s70, s71
    s_add_u32 s29, s29, 32768
    s_cmp_gt_u32 s74, 2
    s_cselect_b32 s30, s68, s69
    s_add_u32 s30, s30, 65536
    s_cmp_gt_u32 s75, 3
    s_cselect_b32 s31, s72, s73
    s_add_u32 s31, s31, 98304
    s_cmp_gt_u32 s74, 4
    s_cselect_b32 s32, s66, s67
    s_add_u32 s32, s32, 131072
    s_cmp_gt_u32 s75, 5
    s_cselect_b32 s33, s70, s71
    s_add_u32 s33, s33, 163840
    s_cmp_gt_u32 s74, 6
    s_cselect_b32 s34, s68, s69
    s_add_u32 s34, s34, 196608
    s_cmp_gt_u32 s75, 7
    s_cselect_b32 s35, s72, s73
    s_add_u32 s35, s35, 229376
    s_cmp_gt_u32 s74, 8
    s_cselect_b32 s36, s66, s67
    s_add_u32 s36, s36, 262144
    s_waitcnt vmcnt(1)
    s_memtime s[62:63]
    s_waitcnt vmcnt(0)
    s_memtime s[66:67]
    buffer_load_dword v12, v11, s[44:47], 0 offen offset:256 sc0 sc1
    buffer_load_dword v9, v8, s[44:47], 0 offen offset:256 sc0 sc1
    s_waitcnt vmcnt(1)
    s_memtime s[68:69]
    s_waitcnt vmcnt(0)
    s_memtime s[70:71]
    s_waitcnt lgkmcnt(0)
    s_sub_u32 s62, s66, s62
    s_sub_u32 s63, s70, s68
    s_sub_u32 s66, s63, s62
    s_min_i32 s66, s66, 400
    s_max_i32 s66, s66, -400
    s_add_u32 s40, s40, 1
    s_add_u32 s41, s41, 1
    s_add_u32 s42, s42, 1
    v_mov_b32 v12, s66
    v_mov_b32 v13, 0
    v_writelane_b32 v13, s40, 1
    v_writelane_b32 v13, s41, 2
    v_writelane_b32 v13, s42, 3
    v_writelane_b32 v13, s40, 5
    v_writelane_b32 v13, s41, 6
    v_writelane_b32 v13, s42, 7
    v_writelane_b32 v13, s40, 9
    v_writelane_b32 v13, s41, 10
    v_writelane_b32 v13, s42, 11
    s_mov_b32 s62, 1638
    s_mov_b32 s63, 2184
    s_bitcmp1_b32 s55, 7
    s_cselect_b32 s62, s63, s62
    s_mov_b32 s63, 0
    s_mov_b64 exec, s[62:63]
    global_store_dwordx2 v10, v[12:13], s[52:53] sc1
    s_mov_b64 exec, -1
    s_barrier
    s_branch L_loads
L_r0_other:
    s_lshr_b32 s62, s39, 1
    s_and_b32 s62, s62, 1
    s_xor_b32 s62, s62, s57
    s_xor_b32 s63, s62, 1
    s_cmp_eq_u32 s39, 4
    s_cselect_b32 s62, s57, s62
    s_cselect_b32 s63, s57, s63
    s_sub_u32 s65, s59, s13
    s_lshl_b32 s62, s62, 1
    s_add_u32 s66, s62, s65
    s_and_b32 s66, s66, 3
    s_lshl_b32 s66, s66, 12
    s_lshl_b32 s63, s63, 1
    s_add_u32 s67, s63, s65
    s_and_b32 s67, s67, 3
    s_lshl_b32 s67, s67, 12
    s_xor_b32 s65, s59, 1
    s_sub_u32 s65, s65, s13
    s_add_u32 s68, s62, s65
    s_and_b32 s68, s68, 3
    s_lshl_b32 s68, s68, 12
    s_add_u32 s69, s63, s65
    s_and_b32 s69, s69, 3
    s_lshl_b32 s69, s69, 12
    s_mov_b32 s62, s39
    s_and_b32 s62, s62, 1
    s_xor_b32 s62, s62, s57
    s_xor_b32 s63, s62, 1
    s_cmp_eq_u32 s39, 4
    s_cselect_b32 s62, s57, s62
    s_cselect_b32 s63, s57, s63
    s_sub_u32 s65, s59, s51
    s_lshl_b32 s62, s62, 1
    s_add_u32 s70, s62, s65
    s_and_b32 s70, s70, 3
    s_lshl_b32 s70, s70, 12
    s_lshl_b32 s63, s63, 1
    s_add_u32 s71, s63, s65
    s_and_b32 s71, s71, 3
    s_lshl_b32 s71, s71, 12
    s_xor_b32 s65, s59, 1
    s_sub_u32 s65, s65, s51
    s_add_u32 s72, s62, s65
    s_and_b32 s72, s72, 3
    s_lshl_b32 s72, s72, 12
    s_add_u32 s73, s63, s65
    s_and_b32 s73, s73, 3
    s_lshl_b32 s73, s73, 12
    s_cmp_lt_u32 s24, 2
    s_cselect_b32 s74, s66, s70
    s_cselect_b32 s70, s70, s66
    s_mov_b32 s66, s74
    s_cselect_b32 s74, s67, s71
    s_cselect_b32 s71, s71, s67
    s_mov_b32 s67, s74
    s_cselect_b32 s74, s68, s72
    s_cselect_b32 s72, s72, s68
    s_mov_b32 s68, s74
    s_cselect_b32 s74, s69, s73
    s_cselect_b32 s73, s73, s69
    s_mov_b32 s69, s74
    s_cselect_b32 s74, s56, s12
    s_cselect_b32 s75, s12, s56
    s_cmp_gt_u32 s74, 0
    s_cselect_b32 s28, s66, s67
    s_cmp_gt_u32 s75, 1
    s_cselect_b32 s29, s70, s71
    s_add_u32 s29, s29, 32768
    s_cmp_gt_u32 s74, 2
    s_cselect_b32 s30, s68, s69
    s_add_u32 s30, s30, 65536
    s_cmp_gt_u32 s75, 3
    s_cselect_b32 s31, s72, s73
    s_add_u32 s31, s31, 98304
    s_cmp_gt_u32 s74, 4
    s_cselect_b32 s32, s66, s67
    s_add_u32 s32, s32, 131072
    s_cmp_gt_u32 s75, 5
    s_cselect_b32 s33, s70, s71
    s_add_u32 s33, s33, 163840
    s_cmp_gt_u32 s74, 6
    s_cselect_b32 s34, s68, s69
    s_add_u32 s34, s34, 196608
    s_cmp_gt_u32 s75, 7
    s_cselect_b32 s35, s72, s73
    s_add_u32 s35, s35, 229376
    s_cmp_gt_u32 s74, 8
    s_cselect_b32 s36, s66, s67
    s_add_u32 s36, s36, 262144
    s_waitcnt lgkmcnt(0)
    s_barrier
    s_branch L_loads
L_reader:
    s_cmp_lg_u32 s24, 0
    s_cbranch_scc1 L_pro_wait
    s_cmp_ge_u32 s2, 768
    s_cselect_b32 s48, 1, 0
    s_lshl_b32 s65, s48, 7
    s_add_u32 s65, s65, 1024
    s_mul_i32 s49, s48, 294912
    s_sub_u32 s49, s49, s61
    s_add_u32 s72, s16, s49
    s_add_u32 s73, s20, s49
    v_mbcnt_lo_u32_b32 v8, -1, 0
    v_lshlrev_b32 v8, 8, v8
    v_add_u32 v8, s65, v8
    s_mov_b32 s61, 200000
    s_sleep 40
    s_cmp_lt_u32 s2, 512
    s_cbranch_scc1 L_ps2
    s_sleep 20
L_ps2:
    s_waitcnt lgkmcnt(0)
    s_add_u32 s60, s50, 1
    s_load_dwordx4 s[28:31], s[52:53], s65 glc
    s_add_u32 s65, s65, 256
    s_load_dwordx4 s[32:35], s[52:53], s65 glc
    s_add_u32 s65, s65, 256
    s_load_dwordx4 s[40:43], s[52:53], s65 glc
    s_add_u32 s65, s65, 256
    s_load_dwordx4 s[44:47], s[52:53], s65 glc
    s_waitcnt lgkmcnt(0)
    s_xor_b32 s62, s29, s60
    s_xor_b32 s63, s31, s60
    s_or_b32 s62, s62, s63
    s_xor_b32 s63, s33, s60
    s_or_b32 s62, s62, s63
    s_xor_b32 s63, s35, s60
    s_or_b32 s62, s62, s63
    s_xor_b32 s63, s41, s60
    s_or_b32 s62, s62, s63
    s_xor_b32 s63, s43, s60
    s_or_b32 s62, s62, s63
    s_xor_b32 s63, s45, s60
    s_or_b32 s62, s62, s63
    s_xor_b32 s63, s47, s60
    s_or_b32 s62, s62, s63
    s_cmp_eq_u32 s62, 0
    s_cbranch_scc1 L_dpoll_ok
    s_sleep 16
    s_add_u32 s65, s65, 256
    s_load_dwordx4 s[28:31], s[52:53], s65 glc
    s_add_u32 s65, s65, 256
    s_load_dwordx4 s[32:35], s[52:53], s65 glc
    s_add_u32 s65, s65, 256
    s_load_dwordx4 s[40:43], s[52:53], s65 glc
    s_add_u32 s65, s65, 256
    s_load_dwordx4 s[44:47], s[52:53], s65 glc
    s_waitcnt lgkmcnt(0)
    s_xor_b32 s62, s29, s60
    s_xor_b32 s63, s31, s60
    s_or_b32 s62, s62, s63
    s_xor_b32 s63, s33, s60
    s_or_b32 s62, s62, s63
    s_xor_b32 s63, s35, s60
    s_or_b32 s62, s62, s63
    s_xor_b32 s63, s41, s60
    s_or_b32 s62, s62, s63
    s_xor_b32 s63, s43, s60
    s_or_b32 s62, s62, s63
    s_xor_b32 s63, s45, s60
    s_or_b32 s62, s62, s63
    s_xor_b32 s63, s47, s60
    s_or_b32 s62, s62, s63
    s_cmp_eq_u32 s62, 0
    s_cbranch_scc1 L_dpoll_ok
    s_sleep 16
    s_add_u32 s65, s65, 256
    s_load_dwordx4 s[28:31], s[52:53], s65 glc
    s_add_u32 s65, s65, 256
    s_load_dwordx4 s[32:35], s[52:53], s65 glc
    s_add_u32 s65, s65, 256
    s_load_dwordx4 s[40:43], s[52:53], s65 glc
    s_add_u32 s65, s65, 256
    s_load_dwordx4 s[44:47], s[52:53], s65 glc
    s_waitcnt lgkmcnt(0)
    s_xor_b32 s62, s29, s60
    s_xor_b32 s63, s31, s60
    s_or_b32 s62, s62, s63
    s_xor_b32 s63, s33, s60
    s_or_b32 s62, s62, s63
    s_xor_b32 s63, s35, s60
    s_or_b32 s62, s62, s63
    s_xor_b32 s63, s41, s60
    s_or_b32 s62, s62, s63
    s_xor_b32 s63, s43, s60
    s_or_b32 s62, s62, s63
    s_xor_b32 s63, s45, s60
    s_or_b32 s62, s62, s63
    s_xor_b32 s63, s47, s60
    s_or_b32 s62, s62, s63
    s_cmp_eq_u32 s62, 0
    s_cbranch_scc1 L_dpoll_ok
    s_mov_b64 exec, 15
L_dpoll:
    global_load_dwordx4 v[12:15], v8, s[52:53] sc1
    s_waitcnt vmcnt(0)
    v_readlane_b32 s28, v12, 0
    v_readlane_b32 s29, v13, 0
    v_readlane_b32 s30, v14, 0
    v_readlane_b32 s31, v15, 0
    v_readlane_b32 s32, v12, 1
    v_readlane_b32 s33, v13, 1
    v_readlane_b32 s34, v14, 1
    v_readlane_b32 s35, v15, 1
    v_readlane_b32 s40, v12, 2
    v_readlane_b32 s41, v13, 2
    v_readlane_b32 s42, v14, 2
    v_readlane_b32 s43, v15, 2
    v_readlane_b32 s44, v12, 3
    v_readlane_b32 s45, v13, 3
    v_readlane_b32 s46, v14, 3
    v_readlane_b32 s47, v15, 3
    s_nop 3
    s_xor_b32 s62, s29, s60
    s_xor_b32 s63, s31, s60
    s_or_b32 s62, s62, s63
    s_xor_b32 s63, s33, s60
    s_or_b32 s62, s62, s63
    s_xor_b32 s63, s35, s60
    s_or_b32 s62, s62, s63
    s_xor_b32 s63, s41, s60
    s_or_b32 s62, s62, s63
    s_xor_b32 s63, s43, s60
    s_or_b32 s62, s62, s63
    s_xor_b32 s63, s45, s60
    s_or_b32 s62, s62, s63
    s_xor_b32 s63, s47, s60
    s_or_b32 s62, s62, s63
    s_cmp_eq_u32 s62, 0
    s_cbranch_scc1 L_dpoll_done
    s_sub_u32 s61, s61, 1
    s_cbranch_scc1 L_dpoll_done
    s_sleep 4
    s_branch L_dpoll
L_dpoll_done:
    s_mov_b64 exec, -1
L_dpoll_ok:
    s_mov_b32 s66, 0
    s_mov_b32 s67, 0
    s_xor_b32 s62, s72, s16
    s_sub_u32 s63, 0, s28
    s_bitcmp1_b32 s62, 21
    s_cselect_b32 s63, s28, s63
    s_add_u32 s66, s66, s63
    s_xor_b32 s62, s73, s20
    s_sub_u32 s63, 0, s30
    s_bitcmp1_b32 s62, 21
    s_cselect_b32 s63, s30, s63
    s_add_u32 s67, s67, s63
    s_add_u32 s72, s72, 589824
    s_add_u32 s73, s73, 589824
    s_xor_b32 s62, s72, s16
    s_sub_u32 s63, 0, s32
    s_bitcmp1_b32 s62, 21
    s_cselect_b32 s63, s32, s63
    s_add_u32 s66, s66, s63
    s_xor_b32 s62, s73, s20
    s_sub_u32 s63, 0, s34
    s_bitcmp1_b32 s62, 21
    s_cselect_b32 s63, s34, s63
    s_add_u32 s67, s67, s63
    s_add_u32 s72, s72, 589824
    s_add_u32 s73, s73, 589824
    s_xor_b32 s62, s72, s16
    s_sub_u32 s63, 0, s40
    s_bitcmp1_b32 s62, 21
    s_cselect_b32 s63, s40, s63
    s_add_u32 s66, s66, s63
    s_xor_b32 s62, s73, s20
    s_sub_u32 s63, 0, s42
    s_bitcmp1_b32 s62, 21
    s_cselect_b32 s63, s42, s63
    s_add_u32 s67, s67, s63
    s_add_u32 s72, s72, 589824
    s_add_u32 s73, s73, 589824
    s_xor_b32 s62, s72, s16
    s_sub_u32 s63, 0, s44
    s_bitcmp1_b32 s62, 21
    s_cselect_b32 s63, s44, s63
    s_add_u32 s66, s66, s63
    s_xor_b32 s62, s73, s20
    s_sub_u32 s63, 0, s46
    s_bitcmp1_b32 s62, 21
    s_cselect_b32 s63, s46, s63
    s_add_u32 s67, s67, s63
    s_cmp_gt_i32 s66, 0
    s_cselect_b32 s62, 0, 1
    s_cmp_gt_i32 s67, 0
    s_cselect_b32 s63, 2, 0
    s_or_b32 s39, s62, s63
    v_mov_b32 v12, s39
    s_mov_b64 exec, 1
    ds_write_b32 v6, v12 offset:32848
    s_mov_b64 exec, -1
    s_waitcnt lgkmcnt(0)
L_pro_wait:
    s_barrier
    ds_read_b32 v12, v6 offset:32848
    s_waitcnt lgkmcnt(0)
    v_readfirstlane_b32 s39, v12
    s_nop 3
    s_lshr_b32 s62, s39, 1
    s_and_b32 s62, s62, 1
    s_xor_b32 s62, s62, s57
    s_xor_b32 s63, s62, 1
    s_cmp_eq_u32 s39, 4
    s_cselect_b32 s62, s57, s62
    s_cselect_b32 s63, s57, s63
    s_sub_u32 s65, s59, s13
    s_lshl_b32 s62, s62, 1
    s_add_u32 s66, s62, s65
    s_and_b32 s66, s66, 3
    s_lshl_b32 s66, s66, 12
    s_lshl_b32 s63, s63, 1
    s_add_u32 s67, s63, s65
    s_and_b32 s67, s67, 3
    s_lshl_b32 s67, s67, 12
    s_xor_b32 s65, s59, 1
    s_sub_u32 s65, s65, s13
    s_add_u32 s68, s62, s65
    s_and_b32 s68, s68, 3
    s_lshl_b32 s68, s68, 12
    s_add_u32 s69, s63, s65
    s_and_b32 s69, s69, 3
    s_lshl_b32 s69, s69, 12
    s_mov_b32 s62, s39
    s_and_b32 s62, s62, 1
    s_xor_b32 s62, s62, s57
    s_xor_b32 s63, s62, 1
    s_cmp_eq_u32 s39, 4
    s_cselect_b32 s62, s57, s62
    s_cselect_b32 s63, s57, s63
    s_sub_u32 s65, s59, s51
    s_lshl_b32 s62, s62, 1
    s_add_u32 s70, s62, s65
    s_and_b32 s70, s70, 3
    s_lshl_b32 s70, s70, 12
    s_lshl_b32 s63, s63, 1
    s_add_u32 s71, s63, s65
    s_and_b32 s71, s71, 3
    s_lshl_b32 s71, s71, 12
    s_xor_b32 s65, s59, 1
    s_sub_u32 s65, s65, s51
    s_add_u32 s72, s62, s65
    s_and_b32 s72, s72, 3
    s_lshl_b32 s72, s72, 12
    s_add_u32 s73, s63, s65
    s_and_b32 s73, s73, 3
    s_lshl_b32 s73, s73, 12
    s_cmp_lt_u32 s24, 2
    s_cselect_b32 s74, s66, s70
    s_cselect_b32 s70, s70, s66
    s_mov_b32 s66, s74
    s_cselect_b32 s74, s67, s71
    s_cselect_b32 s71, s71, s67
    s_mov_b32 s67, s74
    s_cselect_b32 s74, s68, s72
    s_cselect_b32 s72, s72, s68
    s_mov_b32 s68, s74
    s_cselect_b32 s74, s69, s73
    s_cselect_b32 s73, s73, s69
    s_mov_b32 s69, s74
    s_cselect_b32 s74, s56, s12
    s_cselect_b32 s75, s12, s56
    s_cmp_gt_u32 s74, 0
    s_cselect_b32 s28, s66, s67
    s_cmp_gt_u32 s75, 1
    s_cselect_b32 s29, s70, s71
    s_add_u32 s29, s29, 32768
    s_cmp_gt_u32 s74, 2
    s_cselect_b32 s30, s68, s69
    s_add_u32 s30, s30, 65536
    s_cmp_gt_u32 s75, 3
    s_cselect_b32 s31, s72, s73
    s_add_u32 s31, s31, 98304
    s_cmp_gt_u32 s74, 4
    s_cselect_b32 s32, s66, s67
    s_add_u32 s32, s32, 131072
    s_cmp_gt_u32 s75, 5
    s_cselect_b32 s33, s70, s71
    s_add_u32 s33, s33, 163840
    s_cmp_gt_u32 s74, 6
    s_cselect_b32 s34, s68, s69
    s_add_u32 s34, s34, 196608
    s_cmp_gt_u32 s75, 7
    s_cselect_b32 s35, s72, s73
    s_add_u32 s35, s35, 229376
    s_cmp_gt_u32 s74, 8
    s_cselect_b32 s36, s66, s67
    s_add_u32 s36, s36, 262144
L_loads:
    s_add_u32 s50, s50, 1
    s_lshl_b32 s27, s24, 12
    s_mov_b32 m0, s27
    s_mov_b64 exec, 7
    global_load_ushort v10, v4, s[6:7]
    global_load_ushort v11, v4, s[8:9]
    s_mov_b64 exec, -1
    buffer_load_dwordx4 v0, s[16:19], s35 offen nt lds
    buffer_load_dwordx4 v0, s[16:19], s35 offen offset:1024 nt lds
    buffer_load_dwordx4 v0, s[16:19], s35 offen offset:2048 nt lds
    buffer_load_dwordx4 v0, s[16:19], s35 offen offset:3072 nt lds
    s_add_u32 s27, s27, 16384
    s_mov_b32 m0, s27
    s_nop 0
    buffer_load_dwordx4 v0, s[16:19], s36 offen nt lds
    buffer_load_dwordx4 v0, s[16:19], s36 offen offset:1024 nt lds
    buffer_load_dwordx4 v0, s[16:19], s36 offen offset:2048 nt lds
    buffer_load_dwordx4 v0, s[16:19], s36 offen offset:3072 nt lds
    buffer_load_dwordx4 v[16:19], v0, s[16:19], s28 offen nt
    buffer_load_dwordx4 v[20:23], v0, s[16:19], s28 offen offset:1024 nt
    buffer_load_dwordx4 v[24:27], v0, s[16:19], s28 offen offset:2048 nt
    buffer_load_dwordx4 v[28:31], v0, s[16:19], s28 offen offset:3072 nt
    buffer_load_dwordx4 v[32:35], v0, s[16:19], s29 offen nt
    buffer_load_dwordx4 v[36:39], v0, s[16:19], s29 offen offset:1024 nt
    buffer_load_dwordx4 v[40:43], v0, s[16:19], s29 offen offset:2048 nt
    buffer_load_dwordx4 v[44:47], v0, s[16:19], s29 offen offset:3072 nt
    buffer_load_dwordx4 v[48:51], v0, s[16:19], s30 offen nt
    buffer_load_dwordx4 v[52:55], v0, s[16:19], s30 offen offset:1024 nt
    buffer_load_dwordx4 v[56:59], v0, s[16:19], s30 offen offset:2048 nt
    buffer_load_dwordx4 v[60:63], v0, s[16:19], s30 offen offset:3072 nt
    buffer_load_dwordx4 v[64:67], v0, s[16:19], s31 offen nt
    buffer_load_dwordx4 v[68:71], v0, s[16:19], s31 offen offset:1024 nt
    buffer_load_dwordx4 v[72:75], v0, s[16:19], s31 offen offset:2048 nt
    buffer_load_dwordx4 v[76:79], v0, s[16:19], s31 offen offset:3072 nt
    buffer_load_dwordx4 v[80:83], v0, s[16:19], s32 offen nt
    buffer_load_dwordx4 v[84:87], v0, s[16:19], s32 offen offset:1024 nt
    buffer_load_dwordx4 v[88:91], v0, s[16:19], s32 offen offset:2048 nt
    buffer_load_dwordx4 v[92:95], v0, s[16:19], s32 offen offset:3072 nt
    buffer_load_dwordx4 v[96:99], v0, s[16:19], s33 offen nt
    buffer_load_dwordx4 v[100:103], v0, s[16:19], s33 offen offset:1024 nt
    buffer_load_dwordx4 v[104:107], v0, s[16:19], s33 offen offset:2048 nt
    buffer_load_dwordx4 v[108:111], v0, s[16:19], s33 offen offset:3072 nt
    buffer_load_dwordx4 v[112:115], v0, s[16:19], s34 offen nt
    buffer_load_dwordx4 v[116:119], v0, s[16:19], s34 offen offset:1024 nt
    buffer_load_dwordx4 v[120:123], v0, s[16:19], s34 offen offset:2048 nt
    buffer_load_dwordx4 v[124:127], v0, s[16:19], s34 offen offset:3072 nt
    v_mov_b32 v2, 0
    v_mov_b32 v3, 0
    v_mov_b32 v4, 0
    v_mov_b32 v5, 0
    s_waitcnt vmcnt(28)
    v_lshlrev_b32 v10, 16, v10
    v_lshlrev_b32 v11, 16, v11
    s_nop 1
    v_readlane_b32 s44, v10, 0
    v_readlane_b32 s45, v10, 1
    v_readlane_b32 s46, v10, 2
    v_readlane_b32 s47, v11, 0
    v_readlane_b32 s48, v11, 1
    v_readlane_b32 s49, v11, 2
    ds_read_b128 v[8:11], v1
    ds_read_b128 v[12:15], v1 offset:1024
    s_waitcnt lgkmcnt(1)
    v_dot2c_f32_bf16 v2, s37, v8
    v_dot2c_f32_bf16 v3, v8, v8
    v_dot2c_f32_bf16 v4, s37, v9
    v_dot2c_f32_bf16 v5, v9, v9
    v_dot2c_f32_bf16 v2, s37, v10
    v_dot2c_f32_bf16 v3, v10, v10
    v_dot2c_f32_bf16 v4, s37, v11
    v_dot2c_f32_bf16 v5, v11, v11
    ds_read_b128 v[8:11], v1 offset:2048
    s_waitcnt lgkmcnt(1)
    v_dot2c_f32_bf16 v2, s37, v12
    v_dot2c_f32_bf16 v3, v12, v12
    v_dot2c_f32_bf16 v4, s37, v13
    v_dot2c_f32_bf16 v5, v13, v13
    v_dot2c_f32_bf16 v2, s37, v14
    v_dot2c_f32_bf16 v3, v14, v14
    v_dot2c_f32_bf16 v4, s37, v15
    v_dot2c_f32_bf16 v5, v15, v15
    ds_read_b128 v[12:15], v1 offset:3072
    s_waitcnt lgkmcnt(1)
    v_dot2c_f32_bf16 v2, s37, v8
    v_dot2c_f32_bf16 v3, v8, v8
    v_dot2c_f32_bf16 v4, s37, v9
    v_dot2c_f32_bf16 v5, v9, v9
    v_dot2c_f32_bf16 v2, s37, v10
    v_dot2c_f32_bf16 v3, v10, v10
    v_dot2c_f32_bf16 v4, s37, v11
    v_dot2c_f32_bf16 v5, v11, v11
    ds_read_b128 v[8:11], v1 offset:16384
    s_waitcnt lgkmcnt(1)
    v_dot2c_f32_bf16 v2, s37, v12
    v_dot2c_f32_bf16 v3, v12, v12
    v_dot2c_f32_bf16 v4, s37, v13
    v_dot2c_f32_bf16 v5, v13, v13
    v_dot2c_f32_bf16 v2, s37, v14
    v_dot2c_f32_bf16 v3, v14, v14
    v_dot2c_f32_bf16 v4, s37, v15
    v_dot2c_f32_bf16 v5, v15, v15
    ds_read_b128 v[12:15], v1 offset:17408
    s_waitcnt lgkmcnt(1)
    v_dot2c_f32_bf16 v2, s37, v8
    v_dot2c_f32_bf16 v3, v8, v8
    v_dot2c_f32_bf16 v4, s37, v9
    v_dot2c_f32_bf16 v5, v9, v9
    v_dot2c_f32_bf16 v2, s37, v10
    v_dot2c_f32_bf16 v3, v10, v10
    v_dot2c_f32_bf16 v4, s37, v11
    v_dot2c_f32_bf16 v5, v11, v11
    ds_read_b128 v[8:11], v1 offset:18432
    s_waitcnt lgkmcnt(1)
    v_dot2c_f32_bf16 v2, s37, v12
    v_dot2c_f32_bf16 v3, v12, v12
    v_dot2c_f32_bf16 v4, s37, v13
    v_dot2c_f32_bf16 v5, v13, v13
    v_dot2c_f32_bf16 v2, s37, v14
    v_dot2c_f32_bf16 v3, v14, v14
    v_dot2c_f32_bf16 v4, s37, v15
    v_dot2c_f32_bf16 v5, v15, v15
    ds_read_b128 v[12:15], v1 offset:19456
    s_waitcnt lgkmcnt(1)
    v_dot2c_f32_bf16 v2, s37, v8
    v_dot2c_f32_bf16 v3, v8, v8
    v_dot2c_f32_bf16 v4, s37, v9
    v_dot2c_f32_bf16 v5, v9, v9
    v_dot2c_f32_bf16 v2, s37, v10
    v_dot2c_f32_bf16 v3, v10, v10
    v_dot2c_f32_bf16 v4, s37, v11
    v_dot2c_f32_bf16 v5, v11, v11
    s_waitcnt lgkmcnt(0)
    v_dot2c_f32_bf16 v2, s37, v12
    v_dot2c_f32_bf16 v3, v12, v12
    v_dot2c_f32_bf16 v4, s37, v13
    v_dot2c_f32_bf16 v5, v13, v13
    v_dot2c_f32_bf16 v2, s37, v14
    v_dot2c_f32_bf16 v3, v14, v14
    v_dot2c_f32_bf16 v4, s37, v15
    v_dot2c_f32_bf16 v5, v15, v15
    s_waitcnt vmcnt(27)
    v_dot2c_f32_bf16 v2, s37, v16
    v_dot2c_f32_bf16 v3, v16, v16
    v_dot2c_f32_bf16 v4, s37, v17
    v_dot2c_f32_bf16 v5, v17, v17
    v_dot2c_f32_bf16 v2, s37, v18
    v_dot2c_f32_bf16 v3, v18, v18
    v_dot2c_f32_bf16 v4, s37, v19
    v_dot2c_f32_bf16 v5, v19, v19
    s_waitcnt vmcnt(26)
    v_dot2c_f32_bf16 v2, s37, v20
    v_dot2c_f32_bf16 v3, v20, v20
    v_dot2c_f32_bf16 v4, s37, v21
    v_dot2c_f32_bf16 v5, v21, v21
    v_dot2c_f32_bf16 v2, s37, v22
    v_dot2c_f32_bf16 v3, v22, v22
    v_dot2c_f32_bf16 v4, s37, v23
    v_dot2c_f32_bf16 v5, v23, v23
    s_waitcnt vmcnt(25)
    v_dot2c_f32_bf16 v2, s37, v24
    v_dot2c_f32_bf16 v3, v24, v24
    v_dot2c_f32_bf16 v4, s37, v25
    v_dot2c_f32_bf16 v5, v25, v25
    v_dot2c_f32_bf16 v2, s37, v26
    v_dot2c_f32_bf16 v3, v26, v26
    v_dot2c_f32_bf16 v4, s37, v27
    v_dot2c_f32_bf16 v5, v27, v27
    s_waitcnt vmcnt(24)
    v_dot2c_f32_bf16 v2, s37, v28
    v_dot2c_f32_bf16 v3, v28, v28
    v_dot2c_f32_bf16 v4, s37, v29
    v_dot2c_f32_bf16 v5, v29, v29
    v_dot2c_f32_bf16 v2, s37, v30
    v_dot2c_f32_bf16 v3, v30, v30
    v_dot2c_f32_bf16 v4, s37, v31
    v_dot2c_f32_bf16 v5, v31, v31
    s_waitcnt vmcnt(23)
    v_dot2c_f32_bf16 v2, s37, v32
    v_dot2c_f32_bf16 v3, v32, v32
    v_dot2c_f32_bf16 v4, s37, v33
    v_dot2c_f32_bf16 v5, v33, v33
    v_dot2c_f32_bf16 v2, s37, v34
    v_dot2c_f32_bf16 v3, v34, v34
    v_dot2c_f32_bf16 v4, s37, v35
    v_dot2c_f32_bf16 v5, v35, v35
    s_waitcnt vmcnt(22)
    v_dot2c_f32_bf16 v2, s37, v36
    v_dot2c_f32_bf16 v3, v36, v36
    v_dot2c_f32_bf16 v4, s37, v37
    v_dot2c_f32_bf16 v5, v37, v37
    v_dot2c_f32_bf16 v2, s37, v38
    v_dot2c_f32_bf16 v3, v38, v38
    v_dot2c_f32_bf16 v4, s37, v39
    v_dot2c_f32_bf16 v5, v39, v39
    s_waitcnt vmcnt(21)
    v_dot2c_f32_bf16 v2, s37, v40
    v_dot2c_f32_bf16 v3, v40, v40
    v_dot2c_f32_bf16 v4, s37, v41
    v_dot2c_f32_bf16 v5, v41, v41
    v_dot2c_f32_bf16 v2, s37, v42
    v_dot2c_f32_bf16 v3, v42, v42
    v_dot2c_f32_bf16 v4, s37, v43
    v_dot2c_f32_bf16 v5, v43, v43
    s_waitcnt vmcnt(20)
    v_dot2c_f32_bf16 v2, s37, v44
    v_dot2c_f32_bf16 v3, v44, v44
    v_dot2c_f32_bf16 v4, s37, v45
    v_dot2c_f32_bf16 v5, v45, v45
    v_dot2c_f32_bf16 v2, s37, v46
    v_dot2c_f32_bf16 v3, v46, v46
    v_dot2c_f32_bf16 v4, s37, v47
    v_dot2c_f32_bf16 v5, v47, v47
    s_waitcnt vmcnt(19)
    v_dot2c_f32_bf16 v2, s37, v48
    v_dot2c_f32_bf16 v3, v48, v48
    v_dot2c_f32_bf16 v4, s37, v49
    v_dot2c_f32_bf16 v5, v49, v49
    v_dot2c_f32_bf16 v2, s37, v50
    v_dot2c_f32_bf16 v3, v50, v50
    v_dot2c_f32_bf16 v4, s37, v51
    v_dot2c_f32_bf16 v5, v51, v51
    s_waitcnt vmcnt(18)
    v_dot2c_f32_bf16 v2, s37, v52
    v_dot2c_f32_bf16 v3, v52, v52
    v_dot2c_f32_bf16 v4, s37, v53
    v_dot2c_f32_bf16 v5, v53, v53
    v_dot2c_f32_bf16 v2, s37, v54
    v_dot2c_f32_bf16 v3, v54, v54
    v_dot2c_f32_bf16 v4, s37, v55
    v_dot2c_f32_bf16 v5, v55, v55
    s_waitcnt vmcnt(17)
    v_dot2c_f32_bf16 v2, s37, v56
    v_dot2c_f32_bf16 v3, v56, v56
    v_dot2c_f32_bf16 v4, s37, v57
    v_dot2c_f32_bf16 v5, v57, v57
    v_dot2c_f32_bf16 v2, s37, v58
    v_dot2c_f32_bf16 v3, v58, v58
    v_dot2c_f32_bf16 v4, s37, v59
    v_dot2c_f32_bf16 v5, v59, v59
    s_waitcnt vmcnt(16)
    v_dot2c_f32_bf16 v2, s37, v60
    v_dot2c_f32_bf16 v3, v60, v60
    v_dot2c_f32_bf16 v4, s37, v61
    v_dot2c_f32_bf16 v5, v61, v61
    v_dot2c_f32_bf16 v2, s37, v62
    v_dot2c_f32_bf16 v3, v62, v62
    v_dot2c_f32_bf16 v4, s37, v63
    v_dot2c_f32_bf16 v5, v63, v63
    s_waitcnt vmcnt(15)
    v_dot2c_f32_bf16 v2, s37, v64
    v_dot2c_f32_bf16 v3, v64, v64
    v_dot2c_f32_bf16 v4, s37, v65
    v_dot2c_f32_bf16 v5, v65, v65
    v_dot2c_f32_bf16 v2, s37, v66
    v_dot2c_f32_bf16 v3, v66, v66
    v_dot2c_f32_bf16 v4, s37, v67
    v_dot2c_f32_bf16 v5, v67, v67
    s_waitcnt vmcnt(14)
    v_dot2c_f32_bf16 v2, s37, v68
    v_dot2c_f32_bf16 v3, v68, v68
    v_dot2c_f32_bf16 v4, s37, v69
    v_dot2c_f32_bf16 v5, v69, v69
    v_dot2c_f32_bf16 v2, s37, v70
    v_dot2c_f32_bf16 v3, v70, v70
    v_dot2c_f32_bf16 v4, s37, v71
    v_dot2c_f32_bf16 v5, v71, v71
    s_waitcnt vmcnt(13)
    v_dot2c_f32_bf16 v2, s37, v72
    v_dot2c_f32_bf16 v3, v72, v72
    v_dot2c_f32_bf16 v4, s37, v73
    v_dot2c_f32_bf16 v5, v73, v73
    v_dot2c_f32_bf16 v2, s37, v74
    v_dot2c_f32_bf16 v3, v74, v74
    v_dot2c_f32_bf16 v4, s37, v75
    v_dot2c_f32_bf16 v5, v75, v75
    s_waitcnt vmcnt(12)
    v_dot2c_f32_bf16 v2, s37, v76
    v_dot2c_f32_bf16 v3, v76, v76
    v_dot2c_f32_bf16 v4, s37, v77
    v_dot2c_f32_bf16 v5, v77, v77
    v_dot2c_f32_bf16 v2, s37, v78
    v_dot2c_f32_bf16 v3, v78, v78
    v_dot2c_f32_bf16 v4, s37, v79
    v_dot2c_f32_bf16 v5, v79, v79
    s_waitcnt vmcnt(11)
    v_dot2c_f32_bf16 v2, s37, v80
    v_dot2c_f32_bf16 v3, v80, v80
    v_dot2c_f32_bf16 v4, s37, v81
    v_dot2c_f32_bf16 v5, v81, v81
    v_dot2c_f32_bf16 v2, s37, v82
    v_dot2c_f32_bf16 v3, v82, v82
    v_dot2c_f32_bf16 v4, s37, v83
    v_dot2c_f32_bf16 v5, v83, v83
    s_waitcnt vmcnt(10)
    v_dot2c_f32_bf16 v2, s37, v84
    v_dot2c_f32_bf16 v3, v84, v84
    v_dot2c_f32_bf16 v4, s37, v85
    v_dot2c_f32_bf16 v5, v85, v85
    v_dot2c_f32_bf16 v2, s37, v86
    v_dot2c_f32_bf16 v3, v86, v86
    v_dot2c_f32_bf16 v4, s37, v87
    v_dot2c_f32_bf16 v5, v87, v87
    s_waitcnt vmcnt(9)
    v_dot2c_f32_bf16 v2, s37, v88
    v_dot2c_f32_bf16 v3, v88, v88
    v_dot2c_f32_bf16 v4, s37, v89
    v_dot2c_f32_bf16 v5, v89, v89
    v_dot2c_f32_bf16 v2, s37, v90
    v_dot2c_f32_bf16 v3, v90, v90
    v_dot2c_f32_bf16 v4, s37, v91
    v_dot2c_f32_bf16 v5, v91, v91
    s_waitcnt vmcnt(8)
    v_dot2c_f32_bf16 v2, s37, v92
    v_dot2c_f32_bf16 v3, v92, v92
    v_dot2c_f32_bf16 v4, s37, v93
    v_dot2c_f32_bf16 v5, v93, v93
    v_dot2c_f32_bf16 v2, s37, v94
    v_dot2c_f32_bf16 v3, v94, v94
    v_dot2c_f32_bf16 v4, s37, v95
    v_dot2c_f32_bf16 v5, v95, v95
    s_waitcnt vmcnt(7)
    v_dot2c_f32_bf16 v2, s37, v96
    v_dot2c_f32_bf16 v3, v96, v96
    v_dot2c_f32_bf16 v4, s37, v97
    v_dot2c_f32_bf16 v5, v97, v97
    v_dot2c_f32_bf16 v2, s37, v98
    v_dot2c_f32_bf16 v3, v98, v98
    v_dot2c_f32_bf16 v4, s37, v99
    v_dot2c_f32_bf16 v5, v99, v99
    s_waitcnt vmcnt(6)
    v_dot2c_f32_bf16 v2, s37, v100
    v_dot2c_f32_bf16 v3, v100, v100
    v_dot2c_f32_bf16 v4, s37, v101
    v_dot2c_f32_bf16 v5, v101, v101
    v_dot2c_f32_bf16 v2, s37, v102
    v_dot2c_f32_bf16 v3, v102, v102
    v_dot2c_f32_bf16 v4, s37, v103
    v_dot2c_f32_bf16 v5, v103, v103
    s_waitcnt vmcnt(5)
    v_dot2c_f32_bf16 v2, s37, v104
    v_dot2c_f32_bf16 v3, v104, v104
    v_dot2c_f32_bf16 v4, s37, v105
    v_dot2c_f32_bf16 v5, v105, v105
    v_dot2c_f32_bf16 v2, s37, v106
    v_dot2c_f32_bf16 v3, v106, v106
    v_dot2c_f32_bf16 v4, s37, v107
    v_dot2c_f32_bf16 v5, v107, v107
    s_waitcnt vmcnt(4)
    v_dot2c_f32_bf16 v2, s37, v108
    v_dot2c_f32_bf16 v3, v108, v108
    v_dot2c_f32_bf16 v4, s37, v109
    v_dot2c_f32_bf16 v5, v109, v109
    v_dot2c_f32_bf16 v2, s37, v110
    v_dot2c_f32_bf16 v3, v110, v110
    v_dot2c_f32_bf16 v4, s37, v111
    v_dot2c_f32_bf16 v5, v111, v111
    s_waitcnt vmcnt(3)
    v_dot2c_f32_bf16 v2, s37, v112
    v_dot2c_f32_bf16 v3, v112, v112
    v_dot2c_f32_bf16 v4, s37, v113
    v_dot2c_f32_bf16 v5, v113, v113
    v_dot2c_f32_bf16 v2, s37, v114
    v_dot2c_f32_bf16 v3, v114, v114
    v_dot2c_f32_bf16 v4, s37, v115
    v_dot2c_f32_bf16 v5, v115, v115
    s_waitcnt vmcnt(2)
    v_dot2c_f32_bf16 v2, s37, v116
    v_dot2c_f32_bf16 v3, v116, v116
    v_dot2c_f32_bf16 v4, s37, v117
    v_dot2c_f32_bf16 v5, v117, v117
    v_dot2c_f32_bf16 v2, s37, v118
    v_dot2c_f32_bf16 v3, v118, v118
    v_dot2c_f32_bf16 v4, s37, v119
    v_dot2c_f32_bf16 v5, v119, v119
    s_waitcnt vmcnt(1)
    v_dot2c_f32_bf16 v2, s37, v120
    v_dot2c_f32_bf16 v3, v120, v120
    v_dot2c_f32_bf16 v4, s37, v121
    v_dot2c_f32_bf16 v5, v121, v121
    v_dot2c_f32_bf16 v2, s37, v122
    v_dot2c_f32_bf16 v3, v122, v122
    v_dot2c_f32_bf16 v4, s37, v123
    v_dot2c_f32_bf16 v5, v123, v123
    s_waitcnt vmcnt(0)
    v_dot2c_f32_bf16 v2, s37, v124
    v_dot2c_f32_bf16 v3, v124, v124
    v_dot2c_f32_bf16 v4, s37, v125
    v_dot2c_f32_bf16 v5, v125, v125
    v_dot2c_f32_bf16 v2, s37, v126
    v_dot2c_f32_bf16 v3, v126, v126
    v_dot2c_f32_bf16 v4, s37, v127
    v_dot2c_f32_bf16 v5, v127, v127
    s_nop 3
    v_add_f32 v2, v2, v4
    v_add_f32 v3, v3, v5
    s_nop 1
    v_add_f32_dpp v2, v2, v2 row_shr:1 row_mask:0xf bank_mask:0xf
    v_add_f32_dpp v3, v3, v3 row_shr:1 row_mask:0xf bank_mask:0xf
    s_nop 1
    v_add_f32_dpp v2, v2, v2 row_shr:2 row_mask:0xf bank_mask:0xf
    v_add_f32_dpp v3, v3, v3 row_shr:2 row_mask:0xf bank_mask:0xf
    s_nop 1
    v_add_f32_dpp v2, v2, v2 row_shr:4 row_mask:0xf bank_mask:0xf
    v_add_f32_dpp v3, v3, v3 row_shr:4 row_mask:0xf bank_mask:0xf
    s_nop 1
    v_add_f32_dpp v2, v2, v2 row_shr:8 row_mask:0xf bank_mask:0xf
    v_add_f32_dpp v3, v3, v3 row_shr:8 row_mask:0xf bank_mask:0xf
    s_nop 1
    v_add_f32_dpp v2, v2, v2 row_bcast:15 row_mask:0xa bank_mask:0xf
    v_add_f32_dpp v3, v3, v3 row_bcast:15 row_mask:0xa bank_mask:0xf
    s_nop 1
    v_add_f32_dpp v2, v2, v2 row_bcast:31 row_mask:0xc bank_mask:0xf
    v_add_f32_dpp v3, v3, v3 row_bcast:31 row_mask:0xc bank_mask:0xf
    v_lshrrev_b32 v8, 9, v1
    v_and_b32 v8, 24, v8
    s_mov_b32 exec_lo, 0
    s_mov_b32 exec_hi, 0x80000000
    ds_write_b64 v8, v[2:3] offset:32768
    s_mov_b64 exec, -1
    s_waitcnt lgkmcnt(0)
    s_barrier
    s_cmp_lg_u32 s24, 0
    s_cbranch_scc1 L_join
    ds_read_b128 v[8:11], v6 offset:32768
    ds_read_b128 v[12:15], v6 offset:32784
    v_mbcnt_lo_u32_b32 v2, -1, 0
    v_lshlrev_b32 v2, 4, v2
    s_lshl_b32 s60, s26, 4
    v_mov_b32 v7, s60
    s_waitcnt lgkmcnt(0)
    v_add_f32 v8, v8, v10
    v_add_f32 v9, v9, v11
    v_add_f32 v12, v12, v14
    v_add_f32 v13, v13, v15
    v_add_f32 v8, v8, v12
    v_add_f32 v10, v9, v13
    v_mov_b32 v9, s50
    v_mov_b32 v11, s50
    s_mov_b64 exec, 1
    global_store_dwordx4 v7, v[8:11], s[52:53] sc1
    s_mov_b64 exec, 0xffff
    s_mov_b32 s60, 200000
L_poll:
    global_load_dwordx4 v[12:15], v2, s[52:53] sc1
    s_waitcnt vmcnt(0)
    v_cmp_eq_u32 vcc, s50, v13
    v_cmp_eq_u32 s[62:63], s50, v15
    s_nop 1
    s_and_b64 vcc, vcc, s[62:63]
    s_cmp_eq_u32 vcc_lo, 0xffff
    s_cbranch_scc1 L_poll_ok
    s_sub_u32 s60, s60, 1
    s_cbranch_scc1 L_poll_ok
    s_sleep 2
    s_branch L_poll
L_poll_ok:
    s_cmp_lg_u32 s26, 0
    s_cbranch_scc1 L_no_adv
    s_mov_b64 exec, 1
    global_store_dword v6, v9, s[52:53] offset:256 sc1
    s_mov_b64 exec, 0xffff
L_no_adv:
    s_nop 1
    v_add_f32_dpp v12, v12, v12 row_ror:8 row_mask:0xf bank_mask:0xf
    v_add_f32_dpp v14, v14, v14 row_ror:8 row_mask:0xf bank_mask:0xf
    s_nop 1
    v_add_f32_dpp v12, v12, v12 row_ror:4 row_mask:0xf bank_mask:0xf
    v_add_f32_dpp v14, v14, v14 row_ror:4 row_mask:0xf bank_mask:0xf
    s_nop 1
    v_add_f32_dpp v12, v12, v12 row_ror:2 row_mask:0xf bank_mask:0xf
    v_add_f32_dpp v14, v14, v14 row_ror:2 row_mask:0xf bank_mask:0xf
    s_nop 1
    v_add_f32_dpp v12, v12, v12 row_ror:1 row_mask:0xf bank_mask:0xf
    v_add_f32_dpp v14, v14, v14 row_ror:1 row_mask:0xf bank_mask:0xf
    s_nop 1
    v_mul_f32 v12, 0x35638e39, v12
    v_mul_f32 v14, 0x35638e39, v14
    v_fma_f32 v14, -v12, v12, v14
    v_max_f32 v14, 0, v14
    v_add_f32 v14, 0x3727c5ac, v14
    v_rsq_f32 v13, v14
    s_mov_b64 exec, 1
    s_nop 1
    ds_write_b64 v6, v[12:13] offset:32800
    s_cmp_eq_u32 s79, 0
    s_cbranch_scc1 L_gate_done
    s_mov_b64 exec, 0xffff
    s_add_u32 s78, s78, 1
    s_mov_b32 s60, 64
L_gate:
    global_load_dwordx4 v[12:15], v2, s[76:77] sc1
    s_waitcnt vmcnt(0)
    v_cmp_eq_u32 vcc, s78, v13
    v_cmp_eq_u32 s[62:63], s78, v15
    s_nop 1
    s_and_b64 vcc, vcc, s[62:63]
    s_bcnt1_i32_b64 s62, vcc
    s_cmp_ge_u32 s62, 7
    s_cbranch_scc1 L_gate_done
    s_sub_u32 s60, s60, 1
    s_cbranch_scc1 L_gate_done
    s_sleep 3
    s_branch L_gate
L_gate_done:
    s_mov_b64 exec, -1
    s_waitcnt lgkmcnt(0)
L_join:
    s_barrier
    ds_read_b64 v[2:3], v6 offset:32800
    s_setprio 0
    s_waitcnt lgkmcnt(0)
    v_mul_f32 v4, s44, v3
    v_mul_f32 v6, s45, v3
    v_mul_f32 v8, s46, v3
    v_fma_f32 v5, -v2, v4, s47
    v_fma_f32 v7, -v2, v6, s48
    v_fma_f32 v9, -v2, v8, s49
    s_nop 0
    v_readfirstlane_b32 s68, v4
    v_readfirstlane_b32 s69, v5
    v_readfirstlane_b32 s70, v6
    v_readfirstlane_b32 s71, v7
    v_readfirstlane_b32 s72, v8
    v_readfirstlane_b32 s73, v9
    s_nop 3
    s_mov_b64 s[74:75], s[68:69]
    v_lshlrev_b32 v2, 16, v16
    v_and_b32 v3, s38, v16
    v_lshlrev_b32 v4, 16, v17
    v_and_b32 v5, s38, v17
    v_lshlrev_b32 v6, 16, v18
    v_and_b32 v7, s38, v18
    v_lshlrev_b32 v8, 16, v19
    v_and_b32 v9, s38, v19
    v_pk_fma_f32 v[2:3], v[2:3], s[74:75], s[74:75] op_sel:[0,0,1] op_sel_hi:[1,0,1]
    v_pk_fma_f32 v[4:5], v[4:5], s[74:75], s[74:75] op_sel:[0,0,1] op_sel_hi:[1,0,1]
    v_pk_fma_f32 v[6:7], v[6:7], s[74:75], s[74:75] op_sel:[0,0,1] op_sel_hi:[1,0,1]
    v_pk_fma_f32 v[8:9], v[8:9], s[74:75], s[74:75] op_sel:[0,0,1] op_sel_hi:[1,0,1]
    v_cvt_pk_bf16_f32 v16, v2, v3
    v_cvt_pk_bf16_f32 v17, v4, v5
    v_cvt_pk_bf16_f32 v18, v6, v7
    v_cvt_pk_bf16_f32 v19, v8, v9
    buffer_store_dwordx4 v[16:19], v0, s[20:23], s28 offen
    v_lshlrev_b32 v2, 16, v20
    v_and_b32 v3, s38, v20
    v_lshlrev_b32 v4, 16, v21
    v_and_b32 v5, s38, v21
    v_lshlrev_b32 v6, 16, v22
    v_and_b32 v7, s38, v22
    v_lshlrev_b32 v8, 16, v23
    v_and_b32 v9, s38, v23
    v_pk_fma_f32 v[2:3], v[2:3], s[74:75], s[74:75] op_sel:[0,0,1] op_sel_hi:[1,0,1]
    v_pk_fma_f32 v[4:5], v[4:5], s[74:75], s[74:75] op_sel:[0,0,1] op_sel_hi:[1,0,1]
    v_pk_fma_f32 v[6:7], v[6:7], s[74:75], s[74:75] op_sel:[0,0,1] op_sel_hi:[1,0,1]
    v_pk_fma_f32 v[8:9], v[8:9], s[74:75], s[74:75] op_sel:[0,0,1] op_sel_hi:[1,0,1]
    v_cvt_pk_bf16_f32 v20, v2, v3
    v_cvt_pk_bf16_f32 v21, v4, v5
    v_cvt_pk_bf16_f32 v22, v6, v7
    v_cvt_pk_bf16_f32 v23, v8, v9
    buffer_store_dwordx4 v[20:23], v0, s[20:23], s28 offen offset:1024
    v_lshlrev_b32 v2, 16, v24
    v_and_b32 v3, s38, v24
    v_lshlrev_b32 v4, 16, v25
    v_and_b32 v5, s38, v25
    v_lshlrev_b32 v6, 16, v26
    v_and_b32 v7, s38, v26
    v_lshlrev_b32 v8, 16, v27
    v_and_b32 v9, s38, v27
    v_pk_fma_f32 v[2:3], v[2:3], s[74:75], s[74:75] op_sel:[0,0,1] op_sel_hi:[1,0,1]
    v_pk_fma_f32 v[4:5], v[4:5], s[74:75], s[74:75] op_sel:[0,0,1] op_sel_hi:[1,0,1]
    v_pk_fma_f32 v[6:7], v[6:7], s[74:75], s[74:75] op_sel:[0,0,1] op_sel_hi:[1,0,1]
    v_pk_fma_f32 v[8:9], v[8:9], s[74:75], s[74:75] op_sel:[0,0,1] op_sel_hi:[1,0,1]
    v_cvt_pk_bf16_f32 v24, v2, v3
    v_cvt_pk_bf16_f32 v25, v4, v5
    v_cvt_pk_bf16_f32 v26, v6, v7
    v_cvt_pk_bf16_f32 v27, v8, v9
    buffer_store_dwordx4 v[24:27], v0, s[20:23], s28 offen offset:2048
    v_lshlrev_b32 v2, 16, v28
    v_and_b32 v3, s38, v28
    v_lshlrev_b32 v4, 16, v29
    v_and_b32 v5, s38, v29
    v_lshlrev_b32 v6, 16, v30
    v_and_b32 v7, s38, v30
    v_lshlrev_b32 v8, 16, v31
    v_and_b32 v9, s38, v31
    v_pk_fma_f32 v[2:3], v[2:3], s[74:75], s[74:75] op_sel:[0,0,1] op_sel_hi:[1,0,1]
    v_pk_fma_f32 v[4:5], v[4:5], s[74:75], s[74:75] op_sel:[0,0,1] op_sel_hi:[1,0,1]
    v_pk_fma_f32 v[6:7], v[6:7], s[74:75], s[74:75] op_sel:[0,0,1] op_sel_hi:[1,0,1]
    v_pk_fma_f32 v[8:9], v[8:9], s[74:75], s[74:75] op_sel:[0,0,1] op_sel_hi:[1,0,1]
    v_cvt_pk_bf16_f32 v28, v2, v3
    v_cvt_pk_bf16_f32 v29, v4, v5
    v_cvt_pk_bf16_f32 v30, v6, v7
    v_cvt_pk_bf16_f32 v31, v8, v9
    buffer_store_dwordx4 v[28:31], v0, s[20:23], s28 offen offset:3072
    s_cmp_lt_u32 s58, 3
    s_cselect_b64 s[74:75], s[68:69], s[70:71]
    v_lshlrev_b32 v2, 16, v32
    v_and_b32 v3, s38, v32
    v_lshlrev_b32 v4, 16, v33
    v_and_b32 v5, s38, v33
    v_lshlrev_b32 v6, 16, v34
    v_and_b32 v7, s38, v34
    v_lshlrev_b32 v8, 16, v35
    v_and_b32 v9, s38, v35
    v_pk_fma_f32 v[2:3], v[2:3], s[74:75], s[74:75] op_sel:[0,0,1] op_sel_hi:[1,0,1]
    v_pk_fma_f32 v[4:5], v[4:5], s[74:75], s[74:75] op_sel:[0,0,1] op_sel_hi:[1,0,1]
    v_pk_fma_f32 v[6:7], v[6:7], s[74:75], s[74:75] op_sel:[0,0,1] op_sel_hi:[1,0,1]
    v_pk_fma_f32 v[8:9], v[8:9], s[74:75], s[74:75] op_sel:[0,0,1] op_sel_hi:[1,0,1]
    v_cvt_pk_bf16_f32 v32, v2, v3
    v_cvt_pk_bf16_f32 v33, v4, v5
    v_cvt_pk_bf16_f32 v34, v6, v7
    v_cvt_pk_bf16_f32 v35, v8, v9
    buffer_store_dwordx4 v[32:35], v0, s[20:23], s29 offen
    v_lshlrev_b32 v2, 16, v36
    v_and_b32 v3, s38, v36
    v_lshlrev_b32 v4, 16, v37
    v_and_b32 v5, s38, v37
    v_lshlrev_b32 v6, 16, v38
    v_and_b32 v7, s38, v38
    v_lshlrev_b32 v8, 16, v39
    v_and_b32 v9, s38, v39
    v_pk_fma_f32 v[2:3], v[2:3], s[74:75], s[74:75] op_sel:[0,0,1] op_sel_hi:[1,0,1]
    v_pk_fma_f32 v[4:5], v[4:5], s[74:75], s[74:75] op_sel:[0,0,1] op_sel_hi:[1,0,1]
    v_pk_fma_f32 v[6:7], v[6:7], s[74:75], s[74:75] op_sel:[0,0,1] op_sel_hi:[1,0,1]
    v_pk_fma_f32 v[8:9], v[8:9], s[74:75], s[74:75] op_sel:[0,0,1] op_sel_hi:[1,0,1]
    v_cvt_pk_bf16_f32 v36, v2, v3
    v_cvt_pk_bf16_f32 v37, v4, v5
    v_cvt_pk_bf16_f32 v38, v6, v7
    v_cvt_pk_bf16_f32 v39, v8, v9
    buffer_store_dwordx4 v[36:39], v0, s[20:23], s29 offen offset:1024
    v_lshlrev_b32 v2, 16, v40
    v_and_b32 v3, s38, v40
    v_lshlrev_b32 v4, 16, v41
    v_and_b32 v5, s38, v41
    v_lshlrev_b32 v6, 16, v42
    v_and_b32 v7, s38, v42
    v_lshlrev_b32 v8, 16, v43
    v_and_b32 v9, s38, v43
    v_pk_fma_f32 v[2:3], v[2:3], s[74:75], s[74:75] op_sel:[0,0,1] op_sel_hi:[1,0,1]
    v_pk_fma_f32 v[4:5], v[4:5], s[74:75], s[74:75] op_sel:[0,0,1] op_sel_hi:[1,0,1]
    v_pk_fma_f32 v[6:7], v[6:7], s[74:75], s[74:75] op_sel:[0,0,1] op_sel_hi:[1,0,1]
    v_pk_fma_f32 v[8:9], v[8:9], s[74:75], s[74:75] op_sel:[0,0,1] op_sel_hi:[1,0,1]
    v_cvt_pk_bf16_f32 v40, v2, v3
    v_cvt_pk_bf16_f32 v41, v4, v5
    v_cvt_pk_bf16_f32 v42, v6, v7
    v_cvt_pk_bf16_f32 v43, v8, v9
    buffer_store_dwordx4 v[40:43], v0, s[20:23], s29 offen offset:2048
    v_lshlrev_b32 v2, 16, v44
    v_and_b32 v3, s38, v44
    v_lshlrev_b32 v4, 16, v45
    v_and_b32 v5, s38, v45
    v_lshlrev_b32 v6, 16, v46
    v_and_b32 v7, s38, v46
    v_lshlrev_b32 v8, 16, v47
    v_and_b32 v9, s38, v47
    v_pk_fma_f32 v[2:3], v[2:3], s[74:75], s[74:75] op_sel:[0,0,1] op_sel_hi:[1,0,1]
    v_pk_fma_f32 v[4:5], v[4:5], s[74:75], s[74:75] op_sel:[0,0,1] op_sel_hi:[1,0,1]
    v_pk_fma_f32 v[6:7], v[6:7], s[74:75], s[74:75] op_sel:[0,0,1] op_sel_hi:[1,0,1]
    v_pk_fma_f32 v[8:9], v[8:9], s[74:75], s[74:75] op_sel:[0,0,1] op_sel_hi:[1,0,1]
    v_cvt_pk_bf16_f32 v44, v2, v3
    v_cvt_pk_bf16_f32 v45, v4, v5
    v_cvt_pk_bf16_f32 v46, v6, v7
    v_cvt_pk_bf16_f32 v47, v8, v9
    buffer_store_dwordx4 v[44:47], v0, s[20:23], s29 offen offset:3072
    s_cmp_lt_u32 s58, 2
    s_cselect_b64 s[74:75], s[68:69], s[70:71]
    v_lshlrev_b32 v2, 16, v48
    v_and_b32 v3, s38, v48
    v_lshlrev_b32 v4, 16, v49
    v_and_b32 v5, s38, v49
    v_lshlrev_b32 v6, 16, v50
    v_and_b32 v7, s38, v50
    v_lshlrev_b32 v8, 16, v51
    v_and_b32 v9, s38, v51
    v_pk_fma_f32 v[2:3], v[2:3], s[74:75], s[74:75] op_sel:[0,0,1] op_sel_hi:[1,0,1]
    v_pk_fma_f32 v[4:5], v[4:5], s[74:75], s[74:75] op_sel:[0,0,1] op_sel_hi:[1,0,1]
    v_pk_fma_f32 v[6:7], v[6:7], s[74:75], s[74:75] op_sel:[0,0,1] op_sel_hi:[1,0,1]
    v_pk_fma_f32 v[8:9], v[8:9], s[74:75], s[74:75] op_sel:[0,0,1] op_sel_hi:[1,0,1]
    v_cvt_pk_bf16_f32 v48, v2, v3
    v_cvt_pk_bf16_f32 v49, v4, v5
    v_cvt_pk_bf16_f32 v50, v6, v7
    v_cvt_pk_bf16_f32 v51, v8, v9
    buffer_store_dwordx4 v[48:51], v0, s[20:23], s30 offen
    v_lshlrev_b32 v2, 16, v52
    v_and_b32 v3, s38, v52
    v_lshlrev_b32 v4, 16, v53
    v_and_b32 v5, s38, v53
    v_lshlrev_b32 v6, 16, v54
    v_and_b32 v7, s38, v54
    v_lshlrev_b32 v8, 16, v55
    v_and_b32 v9, s38, v55
    v_pk_fma_f32 v[2:3], v[2:3], s[74:75], s[74:75] op_sel:[0,0,1] op_sel_hi:[1,0,1]
    v_pk_fma_f32 v[4:5], v[4:5], s[74:75], s[74:75] op_sel:[0,0,1] op_sel_hi:[1,0,1]
    v_pk_fma_f32 v[6:7], v[6:7], s[74:75], s[74:75] op_sel:[0,0,1] op_sel_hi:[1,0,1]
    v_pk_fma_f32 v[8:9], v[8:9], s[74:75], s[74:75] op_sel:[0,0,1] op_sel_hi:[1,0,1]
    v_cvt_pk_bf16_f32 v52, v2, v3
    v_cvt_pk_bf16_f32 v53, v4, v5
    v_cvt_pk_bf16_f32 v54, v6, v7
    v_cvt_pk_bf16_f32 v55, v8, v9
    buffer_store_dwordx4 v[52:55], v0, s[20:23], s30 offen offset:1024
    v_lshlrev_b32 v2, 16, v56
    v_and_b32 v3, s38, v56
    v_lshlrev_b32 v4, 16, v57
    v_and_b32 v5, s38, v57
    v_lshlrev_b32 v6, 16, v58
    v_and_b32 v7, s38, v58
    v_lshlrev_b32 v8, 16, v59
    v_and_b32 v9, s38, v59
    v_pk_fma_f32 v[2:3], v[2:3], s[74:75], s[74:75] op_sel:[0,0,1] op_sel_hi:[1,0,1]
    v_pk_fma_f32 v[4:5], v[4:5], s[74:75], s[74:75] op_sel:[0,0,1] op_sel_hi:[1,0,1]
    v_pk_fma_f32 v[6:7], v[6:7], s[74:75], s[74:75] op_sel:[0,0,1] op_sel_hi:[1,0,1]
    v_pk_fma_f32 v[8:9], v[8:9], s[74:75], s[74:75] op_sel:[0,0,1] op_sel_hi:[1,0,1]
    v_cvt_pk_bf16_f32 v56, v2, v3
    v_cvt_pk_bf16_f32 v57, v4, v5
    v_cvt_pk_bf16_f32 v58, v6, v7
    v_cvt_pk_bf16_f32 v59, v8, v9
    buffer_store_dwordx4 v[56:59], v0, s[20:23], s30 offen offset:2048
    v_lshlrev_b32 v2, 16, v60
    v_and_b32 v3, s38, v60
    v_lshlrev_b32 v4, 16, v61
    v_and_b32 v5, s38, v61
    v_lshlrev_b32 v6, 16, v62
    v_and_b32 v7, s38, v62
    v_lshlrev_b32 v8, 16, v63
    v_and_b32 v9, s38, v63
    v_pk_fma_f32 v[2:3], v[2:3], s[74:75], s[74:75] op_sel:[0,0,1] op_sel_hi:[1,0,1]
    v_pk_fma_f32 v[4:5], v[4:5], s[74:75], s[74:75] op_sel:[0,0,1] op_sel_hi:[1,0,1]
    v_pk_fma_f32 v[6:7], v[6:7], s[74:75], s[74:75] op_sel:[0,0,1] op_sel_hi:[1,0,1]
    v_pk_fma_f32 v[8:9], v[8:9], s[74:75], s[74:75] op_sel:[0,0,1] op_sel_hi:[1,0,1]
    v_cvt_pk_bf16_f32 v60, v2, v3
    v_cvt_pk_bf16_f32 v61, v4, v5
    v_cvt_pk_bf16_f32 v62, v6, v7
    v_cvt_pk_bf16_f32 v63, v8, v9
    buffer_store_dwordx4 v[60:63], v0, s[20:23], s30 offen offset:3072
    ds_read_b128 v[16:19], v1 offset:0
    ds_read_b128 v[20:23], v1 offset:1024
    ds_read_b128 v[24:27], v1 offset:2048
    ds_read_b128 v[28:31], v1 offset:3072
    ds_read_b128 v[32:35], v1 offset:16384
    ds_read_b128 v[36:39], v1 offset:17408
    ds_read_b128 v[40:43], v1 offset:18432
    ds_read_b128 v[44:47], v1 offset:19456
    s_cmp_lt_u32 s58, 1
    s_cselect_b64 s[74:75], s[68:69], s[70:71]
    v_lshlrev_b32 v2, 16, v64
    v_and_b32 v3, s38, v64
    v_lshlrev_b32 v4, 16, v65
    v_and_b32 v5, s38, v65
    v_lshlrev_b32 v6, 16, v66
    v_and_b32 v7, s38, v66
    v_lshlrev_b32 v8, 16, v67
    v_and_b32 v9, s38, v67
    v_pk_fma_f32 v[2:3], v[2:3], s[74:75], s[74:75] op_sel:[0,0,1] op_sel_hi:[1,0,1]
    v_pk_fma_f32 v[4:5], v[4:5], s[74:75], s[74:75] op_sel:[0,0,1] op_sel_hi:[1,0,1]
    v_pk_fma_f32 v[6:7], v[6:7], s[74:75], s[74:75] op_sel:[0,0,1] op_sel_hi:[1,0,1]
    v_pk_fma_f32 v[8:9], v[8:9], s[74:75], s[74:75] op_sel:[0,0,1] op_sel_hi:[1,0,1]
    v_cvt_pk_bf16_f32 v64, v2, v3
    v_cvt_pk_bf16_f32 v65, v4, v5
    v_cvt_pk_bf16_f32 v66, v6, v7
    v_cvt_pk_bf16_f32 v67, v8, v9
    buffer_store_dwordx4 v[64:67], v0, s[20:23], s31 offen
    v_lshlrev_b32 v2, 16, v68
    v_and_b32 v3, s38, v68
    v_lshlrev_b32 v4, 16, v69
    v_and_b32 v5, s38, v69
    v_lshlrev_b32 v6, 16, v70
    v_and_b32 v7, s38, v70
    v_lshlrev_b32 v8, 16, v71
    v_and_b32 v9, s38, v71
    v_pk_fma_f32 v[2:3], v[2:3], s[74:75], s[74:75] op_sel:[0,0,1] op_sel_hi:[1,0,1]
    v_pk_fma_f32 v[4:5], v[4:5], s[74:75], s[74:75] op_sel:[0,0,1] op_sel_hi:[1,0,1]
    v_pk_fma_f32 v[6:7], v[6:7], s[74:75], s[74:75] op_sel:[0,0,1] op_sel_hi:[1,0,1]
    v_pk_fma_f32 v[8:9], v[8:9], s[74:75], s[74:75] op_sel:[0,0,1] op_sel_hi:[1,0,1]
    v_cvt_pk_bf16_f32 v68, v2, v3
    v_cvt_pk_bf16_f32 v69, v4, v5
    v_cvt_pk_bf16_f32 v70, v6, v7
    v_cvt_pk_bf16_f32 v71, v8, v9
    buffer_store_dwordx4 v[68:71], v0, s[20:23], s31 offen offset:1024
    v_lshlrev_b32 v2, 16, v72
    v_and_b32 v3, s38, v72
    v_lshlrev_b32 v4, 16, v73
    v_and_b32 v5, s38, v73
    v_lshlrev_b32 v6, 16, v74
    v_and_b32 v7, s38, v74
    v_lshlrev_b32 v8, 16, v75
    v_and_b32 v9, s38, v75
    v_pk_fma_f32 v[2:3], v[2:3], s[74:75], s[74:75] op_sel:[0,0,1] op_sel_hi:[1,0,1]
    v_pk_fma_f32 v[4:5], v[4:5], s[74:75], s[74:75] op_sel:[0,0,1] op_sel_hi:[1,0,1]
    v_pk_fma_f32 v[6:7], v[6:7], s[74:75], s[74:75] op_sel:[0,0,1] op_sel_hi:[1,0,1]
    v_pk_fma_f32 v[8:9], v[8:9], s[74:75], s[74:75] op_sel:[0,0,1] op_sel_hi:[1,0,1]
    v_cvt_pk_bf16_f32 v72, v2, v3
    v_cvt_pk_bf16_f32 v73, v4, v5
    v_cvt_pk_bf16_f32 v74, v6, v7
    v_cvt_pk_bf16_f32 v75, v8, v9
    buffer_store_dwordx4 v[72:75], v0, s[20:23], s31 offen offset:2048
    v_lshlrev_b32 v2, 16, v76
    v_and_b32 v3, s38, v76
    v_lshlrev_b32 v4, 16, v77
    v_and_b32 v5, s38, v77
    v_lshlrev_b32 v6, 16, v78
    v_and_b32 v7, s38, v78
    v_lshlrev_b32 v8, 16, v79
    v_and_b32 v9, s38, v79
    v_pk_fma_f32 v[2:3], v[2:3], s[74:75], s[74:75] op_sel:[0,0,1] op_sel_hi:[1,0,1]
    v_pk_fma_f32 v[4:5], v[4:5], s[74:75], s[74:75] op_sel:[0,0,1] op_sel_hi:[1,0,1]
    v_pk_fma_f32 v[6:7], v[6:7], s[74:75], s[74:75] op_sel:[0,0,1] op_sel_hi:[1,0,1]
    v_pk_fma_f32 v[8:9], v[8:9], s[74:75], s[74:75] op_sel:[0,0,1] op_sel_hi:[1,0,1]
    v_cvt_pk_bf16_f32 v76, v2, v3
    v_cvt_pk_bf16_f32 v77, v4, v5
    v_cvt_pk_bf16_f32 v78, v6, v7
    v_cvt_pk_bf16_f32 v79, v8, v9
    buffer_store_dwordx4 v[76:79], v0, s[20:23], s31 offen offset:3072
    s_mov_b64 s[74:75], s[70:71]
    v_lshlrev_b32 v2, 16, v80
    v_and_b32 v3, s38, v80
    v_lshlrev_b32 v4, 16, v81
    v_and_b32 v5, s38, v81
    v_lshlrev_b32 v6, 16, v82
    v_and_b32 v7, s38, v82
    v_lshlrev_b32 v8, 16, v83
    v_and_b32 v9, s38, v83
    v_pk_fma_f32 v[2:3], v[2:3], s[74:75], s[74:75] op_sel:[0,0,1] op_sel_hi:[1,0,1]
    v_pk_fma_f32 v[4:5], v[4:5], s[74:75], s[74:75] op_sel:[0,0,1] op_sel_hi:[1,0,1]
    v_pk_fma_f32 v[6:7], v[6:7], s[74:75], s[74:75] op_sel:[0,0,1] op_sel_hi:[1,0,1]
    v_pk_fma_f32 v[8:9], v[8:9], s[74:75], s[74:75] op_sel:[0,0,1] op_sel_hi:[1,0,1]
    v_cvt_pk_bf16_f32 v80, v2, v3
    v_cvt_pk_bf16_f32 v81, v4, v5
    v_cvt_pk_bf16_f32 v82, v6, v7
    v_cvt_pk_bf16_f32 v83, v8, v9
    buffer_store_dwordx4 v[80:83], v0, s[20:23], s32 offen
    v_lshlrev_b32 v2, 16, v84
    v_and_b32 v3, s38, v84
    v_lshlrev_b32 v4, 16, v85
    v_and_b32 v5, s38, v85
    v_lshlrev_b32 v6, 16, v86
    v_and_b32 v7, s38, v86
    v_lshlrev_b32 v8, 16, v87
    v_and_b32 v9, s38, v87
    v_pk_fma_f32 v[2:3], v[2:3], s[74:75], s[74:75] op_sel:[0,0,1] op_sel_hi:[1,0,1]
    v_pk_fma_f32 v[4:5], v[4:5], s[74:75], s[74:75] op_sel:[0,0,1] op_sel_hi:[1,0,1]
    v_pk_fma_f32 v[6:7], v[6:7], s[74:75], s[74:75] op_sel:[0,0,1] op_sel_hi:[1,0,1]
    v_pk_fma_f32 v[8:9], v[8:9], s[74:75], s[74:75] op_sel:[0,0,1] op_sel_hi:[1,0,1]
    v_cvt_pk_bf16_f32 v84, v2, v3
    v_cvt_pk_bf16_f32 v85, v4, v5
    v_cvt_pk_bf16_f32 v86, v6, v7
    v_cvt_pk_bf16_f32 v87, v8, v9
    buffer_store_dwordx4 v[84:87], v0, s[20:23], s32 offen offset:1024
    v_lshlrev_b32 v2, 16, v88
    v_and_b32 v3, s38, v88
    v_lshlrev_b32 v4, 16, v89
    v_and_b32 v5, s38, v89
    v_lshlrev_b32 v6, 16, v90
    v_and_b32 v7, s38, v90
    v_lshlrev_b32 v8, 16, v91
    v_and_b32 v9, s38, v91
    v_pk_fma_f32 v[2:3], v[2:3], s[74:75], s[74:75] op_sel:[0,0,1] op_sel_hi:[1,0,1]
    v_pk_fma_f32 v[4:5], v[4:5], s[74:75], s[74:75] op_sel:[0,0,1] op_sel_hi:[1,0,1]
    v_pk_fma_f32 v[6:7], v[6:7], s[74:75], s[74:75] op_sel:[0,0,1] op_sel_hi:[1,0,1]
    v_pk_fma_f32 v[8:9], v[8:9], s[74:75], s[74:75] op_sel:[0,0,1] op_sel_hi:[1,0,1]
    v_cvt_pk_bf16_f32 v88, v2, v3
    v_cvt_pk_bf16_f32 v89, v4, v5
    v_cvt_pk_bf16_f32 v90, v6, v7
    v_cvt_pk_bf16_f32 v91, v8, v9
    buffer_store_dwordx4 v[88:91], v0, s[20:23], s32 offen offset:2048
    v_lshlrev_b32 v2, 16, v92
    v_and_b32 v3, s38, v92
    v_lshlrev_b32 v4, 16, v93
    v_and_b32 v5, s38, v93
    v_lshlrev_b32 v6, 16, v94
    v_and_b32 v7, s38, v94
    v_lshlrev_b32 v8, 16, v95
    v_and_b32 v9, s38, v95
    v_pk_fma_f32 v[2:3], v[2:3], s[74:75], s[74:75] op_sel:[0,0,1] op_sel_hi:[1,0,1]
    v_pk_fma_f32 v[4:5], v[4:5], s[74:75], s[74:75] op_sel:[0,0,1] op_sel_hi:[1,0,1]
    v_pk_fma_f32 v[6:7], v[6:7], s[74:75], s[74:75] op_sel:[0,0,1] op_sel_hi:[1,0,1]
    v_pk_fma_f32 v[8:9], v[8:9], s[74:75], s[74:75] op_sel:[0,0,1] op_sel_hi:[1,0,1]
    v_cvt_pk_bf16_f32 v92, v2, v3
    v_cvt_pk_bf16_f32 v93, v4, v5
    v_cvt_pk_bf16_f32 v94, v6, v7
    v_cvt_pk_bf16_f32 v95, v8, v9
    buffer_store_dwordx4 v[92:95], v0, s[20:23], s32 offen offset:3072
    s_cmp_lt_u32 s58, 3
    s_cselect_b64 s[74:75], s[70:71], s[72:73]
    v_lshlrev_b32 v2, 16, v96
    v_and_b32 v3, s38, v96
    v_lshlrev_b32 v4, 16, v97
    v_and_b32 v5, s38, v97
    v_lshlrev_b32 v6, 16, v98
    v_and_b32 v7, s38, v98
    v_lshlrev_b32 v8, 16, v99
    v_and_b32 v9, s38, v99
    v_pk_fma_f32 v[2:3], v[2:3], s[74:75], s[74:75] op_sel:[0,0,1] op_sel_hi:[1,0,1]
    v_pk_fma_f32 v[4:5], v[4:5], s[74:75], s[74:75] op_sel:[0,0,1] op_sel_hi:[1,0,1]
    v_pk_fma_f32 v[6:7], v[6:7], s[74:75], s[74:75] op_sel:[0,0,1] op_sel_hi:[1,0,1]
    v_pk_fma_f32 v[8:9], v[8:9], s[74:75], s[74:75] op_sel:[0,0,1] op_sel_hi:[1,0,1]
    v_cvt_pk_bf16_f32 v96, v2, v3
    v_cvt_pk_bf16_f32 v97, v4, v5
    v_cvt_pk_bf16_f32 v98, v6, v7
    v_cvt_pk_bf16_f32 v99, v8, v9
    buffer_store_dwordx4 v[96:99], v0, s[20:23], s33 offen
    v_lshlrev_b32 v2, 16, v100
    v_and_b32 v3, s38, v100
    v_lshlrev_b32 v4, 16, v101
    v_and_b32 v5, s38, v101
    v_lshlrev_b32 v6, 16, v102
    v_and_b32 v7, s38, v102
    v_lshlrev_b32 v8, 16, v103
    v_and_b32 v9, s38, v103
    v_pk_fma_f32 v[2:3], v[2:3], s[74:75], s[74:75] op_sel:[0,0,1] op_sel_hi:[1,0,1]
    v_pk_fma_f32 v[4:5], v[4:5], s[74:75], s[74:75] op_sel:[0,0,1] op_sel_hi:[1,0,1]
    v_pk_fma_f32 v[6:7], v[6:7], s[74:75], s[74:75] op_sel:[0,0,1] op_sel_hi:[1,0,1]
    v_pk_fma_f32 v[8:9], v[8:9], s[74:75], s[74:75] op_sel:[0,0,1] op_sel_hi:[1,0,1]
    v_cvt_pk_bf16_f32 v100, v2, v3
    v_cvt_pk_bf16_f32 v101, v4, v5
    v_cvt_pk_bf16_f32 v102, v6, v7
    v_cvt_pk_bf16_f32 v103, v8, v9
    buffer_store_dwordx4 v[100:103], v0, s[20:23], s33 offen offset:1024
    v_lshlrev_b32 v2, 16, v104
    v_and_b32 v3, s38, v104
    v_lshlrev_b32 v4, 16, v105
    v_and_b32 v5, s38, v105
    v_lshlrev_b32 v6, 16, v106
    v_and_b32 v7, s38, v106
    v_lshlrev_b32 v8, 16, v107
    v_and_b32 v9, s38, v107
    v_pk_fma_f32 v[2:3], v[2:3], s[74:75], s[74:75] op_sel:[0,0,1] op_sel_hi:[1,0,1]
    v_pk_fma_f32 v[4:5], v[4:5], s[74:75], s[74:75] op_sel:[0,0,1] op_sel_hi:[1,0,1]
    v_pk_fma_f32 v[6:7], v[6:7], s[74:75], s[74:75] op_sel:[0,0,1] op_sel_hi:[1,0,1]
    v_pk_fma_f32 v[8:9], v[8:9], s[74:75], s[74:75] op_sel:[0,0,1] op_sel_hi:[1,0,1]
    v_cvt_pk_bf16_f32 v104, v2, v3
    v_cvt_pk_bf16_f32 v105, v4, v5
    v_cvt_pk_bf16_f32 v106, v6, v7
    v_cvt_pk_bf16_f32 v107, v8, v9
    buffer_store_dwordx4 v[104:107], v0, s[20:23], s33 offen offset:2048
    v_lshlrev_b32 v2, 16, v108
    v_and_b32 v3, s38, v108
    v_lshlrev_b32 v4, 16, v109
    v_and_b32 v5, s38, v109
    v_lshlrev_b32 v6, 16, v110
    v_and_b32 v7, s38, v110
    v_lshlrev_b32 v8, 16, v111
    v_and_b32 v9, s38, v111
    v_pk_fma_f32 v[2:3], v[2:3], s[74:75], s[74:75] op_sel:[0,0,1] op_sel_hi:[1,0,1]
    v_pk_fma_f32 v[4:5], v[4:5], s[74:75], s[74:75] op_sel:[0,0,1] op_sel_hi:[1,0,1]
    v_pk_fma_f32 v[6:7], v[6:7], s[74:75], s[74:75] op_sel:[0,0,1] op_sel_hi:[1,0,1]
    v_pk_fma_f32 v[8:9], v[8:9], s[74:75], s[74:75] op_sel:[0,0,1] op_sel_hi:[1,0,1]
    v_cvt_pk_bf16_f32 v108, v2, v3
    v_cvt_pk_bf16_f32 v109, v4, v5
    v_cvt_pk_bf16_f32 v110, v6, v7
    v_cvt_pk_bf16_f32 v111, v8, v9
    buffer_store_dwordx4 v[108:111], v0, s[20:23], s33 offen offset:3072
    s_cmp_lt_u32 s58, 2
    s_cselect_b64 s[74:75], s[70:71], s[72:73]
    v_lshlrev_b32 v2, 16, v112
    v_and_b32 v3, s38, v112
    v_lshlrev_b32 v4, 16, v113
    v_and_b32 v5, s38, v113
    v_lshlrev_b32 v6, 16, v114
    v_and_b32 v7, s38, v114
    v_lshlrev_b32 v8, 16, v115
    v_and_b32 v9, s38, v115
    v_pk_fma_f32 v[2:3], v[2:3], s[74:75], s[74:75] op_sel:[0,0,1] op_sel_hi:[1,0,1]
    v_pk_fma_f32 v[4:5], v[4:5], s[74:75], s[74:75] op_sel:[0,0,1] op_sel_hi:[1,0,1]
    v_pk_fma_f32 v[6:7], v[6:7], s[74:75], s[74:75] op_sel:[0,0,1] op_sel_hi:[1,0,1]
    v_pk_fma_f32 v[8:9], v[8:9], s[74:75], s[74:75] op_sel:[0,0,1] op_sel_hi:[1,0,1]
    v_cvt_pk_bf16_f32 v112, v2, v3
    v_cvt_pk_bf16_f32 v113, v4, v5
    v_cvt_pk_bf16_f32 v114, v6, v7
    v_cvt_pk_bf16_f32 v115, v8, v9
    buffer_store_dwordx4 v[112:115], v0, s[20:23], s34 offen
    v_lshlrev_b32 v2, 16, v116
    v_and_b32 v3, s38, v116
    v_lshlrev_b32 v4, 16, v117
    v_and_b32 v5, s38, v117
    v_lshlrev_b32 v6, 16, v118
    v_and_b32 v7, s38, v118
    v_lshlrev_b32 v8, 16, v119
    v_and_b32 v9, s38, v119
    v_pk_fma_f32 v[2:3], v[2:3], s[74:75], s[74:75] op_sel:[0,0,1] op_sel_hi:[1,0,1]
    v_pk_fma_f32 v[4:5], v[4:5], s[74:75], s[74:75] op_sel:[0,0,1] op_sel_hi:[1,0,1]
    v_pk_fma_f32 v[6:7], v[6:7], s[74:75], s[74:75] op_sel:[0,0,1] op_sel_hi:[1,0,1]
    v_pk_fma_f32 v[8:9], v[8:9], s[74:75], s[74:75] op_sel:[0,0,1] op_sel_hi:[1,0,1]
    v_cvt_pk_bf16_f32 v116, v2, v3
    v_cvt_pk_bf16_f32 v117, v4, v5
    v_cvt_pk_bf16_f32 v118, v6, v7
    v_cvt_pk_bf16_f32 v119, v8, v9
    buffer_store_dwordx4 v[116:119], v0, s[20:23], s34 offen offset:1024
    v_lshlrev_b32 v2, 16, v120
    v_and_b32 v3, s38, v120
    v_lshlrev_b32 v4, 16, v121
    v_and_b32 v5, s38, v121
    v_lshlrev_b32 v6, 16, v122
    v_and_b32 v7, s38, v122
    v_lshlrev_b32 v8, 16, v123
    v_and_b32 v9, s38, v123
    v_pk_fma_f32 v[2:3], v[2:3], s[74:75], s[74:75] op_sel:[0,0,1] op_sel_hi:[1,0,1]
    v_pk_fma_f32 v[4:5], v[4:5], s[74:75], s[74:75] op_sel:[0,0,1] op_sel_hi:[1,0,1]
    v_pk_fma_f32 v[6:7], v[6:7], s[74:75], s[74:75] op_sel:[0,0,1] op_sel_hi:[1,0,1]
    v_pk_fma_f32 v[8:9], v[8:9], s[74:75], s[74:75] op_sel:[0,0,1] op_sel_hi:[1,0,1]
    v_cvt_pk_bf16_f32 v120, v2, v3
    v_cvt_pk_bf16_f32 v121, v4, v5
    v_cvt_pk_bf16_f32 v122, v6, v7
    v_cvt_pk_bf16_f32 v123, v8, v9
    buffer_store_dwordx4 v[120:123], v0, s[20:23], s34 offen offset:2048
    v_lshlrev_b32 v2, 16, v124
    v_and_b32 v3, s38, v124
    v_lshlrev_b32 v4, 16, v125
    v_and_b32 v5, s38, v125
    v_lshlrev_b32 v6, 16, v126
    v_and_b32 v7, s38, v126
    v_lshlrev_b32 v8, 16, v127
    v_and_b32 v9, s38, v127
    v_pk_fma_f32 v[2:3], v[2:3], s[74:75], s[74:75] op_sel:[0,0,1] op_sel_hi:[1,0,1]
    v_pk_fma_f32 v[4:5], v[4:5], s[74:75], s[74:75] op_sel:[0,0,1] op_sel_hi:[1,0,1]
    v_pk_fma_f32 v[6:7], v[6:7], s[74:75], s[74:75] op_sel:[0,0,1] op_sel_hi:[1,0,1]
    v_pk_fma_f32 v[8:9], v[8:9], s[74:75], s[74:75] op_sel:[0,0,1] op_sel_hi:[1,0,1]
    v_cvt_pk_bf16_f32 v124, v2, v3
    v_cvt_pk_bf16_f32 v125, v4, v5
    v_cvt_pk_bf16_f32 v126, v6, v7
    v_cvt_pk_bf16_f32 v127, v8, v9
    buffer_store_dwordx4 v[124:127], v0, s[20:23], s34 offen offset:3072
    s_waitcnt lgkmcnt(0)
    s_cmp_lt_u32 s58, 1
    s_cselect_b64 s[74:75], s[70:71], s[72:73]
    v_lshlrev_b32 v2, 16, v16
    v_and_b32 v3, s38, v16
    v_lshlrev_b32 v4, 16, v17
    v_and_b32 v5, s38, v17
    v_lshlrev_b32 v6, 16, v18
    v_and_b32 v7, s38, v18
    v_lshlrev_b32 v8, 16, v19
    v_and_b32 v9, s38, v19
    v_pk_fma_f32 v[2:3], v[2:3], s[74:75], s[74:75] op_sel:[0,0,1] op_sel_hi:[1,0,1]
    v_pk_fma_f32 v[4:5], v[4:5], s[74:75], s[74:75] op_sel:[0,0,1] op_sel_hi:[1,0,1]
    v_pk_fma_f32 v[6:7], v[6:7], s[74:75], s[74:75] op_sel:[0,0,1] op_sel_hi:[1,0,1]
    v_pk_fma_f32 v[8:9], v[8:9], s[74:75], s[74:75] op_sel:[0,0,1] op_sel_hi:[1,0,1]
    v_cvt_pk_bf16_f32 v16, v2, v3
    v_cvt_pk_bf16_f32 v17, v4, v5
    v_cvt_pk_bf16_f32 v18, v6, v7
    v_cvt_pk_bf16_f32 v19, v8, v9
    buffer_store_dwordx4 v[16:19], v0, s[20:23], s35 offen
    v_lshlrev_b32 v2, 16, v20
    v_and_b32 v3, s38, v20
    v_lshlrev_b32 v4, 16, v21
    v_and_b32 v5, s38, v21
    v_lshlrev_b32 v6, 16, v22
    v_and_b32 v7, s38, v22
    v_lshlrev_b32 v8, 16, v23
    v_and_b32 v9, s38, v23
    v_pk_fma_f32 v[2:3], v[2:3], s[74:75], s[74:75] op_sel:[0,0,1] op_sel_hi:[1,0,1]
    v_pk_fma_f32 v[4:5], v[4:5], s[74:75], s[74:75] op_sel:[0,0,1] op_sel_hi:[1,0,1]
    v_pk_fma_f32 v[6:7], v[6:7], s[74:75], s[74:75] op_sel:[0,0,1] op_sel_hi:[1,0,1]
    v_pk_fma_f32 v[8:9], v[8:9], s[74:75], s[74:75] op_sel:[0,0,1] op_sel_hi:[1,0,1]
    v_cvt_pk_bf16_f32 v20, v2, v3
    v_cvt_pk_bf16_f32 v21, v4, v5
    v_cvt_pk_bf16_f32 v22, v6, v7
    v_cvt_pk_bf16_f32 v23, v8, v9
    buffer_store_dwordx4 v[20:23], v0, s[20:23], s35 offen offset:1024
    v_lshlrev_b32 v2, 16, v24
    v_and_b32 v3, s38, v24
    v_lshlrev_b32 v4, 16, v25
    v_and_b32 v5, s38, v25
    v_lshlrev_b32 v6, 16, v26
    v_and_b32 v7, s38, v26
    v_lshlrev_b32 v8, 16, v27
    v_and_b32 v9, s38, v27
    v_pk_fma_f32 v[2:3], v[2:3], s[74:75], s[74:75] op_sel:[0,0,1] op_sel_hi:[1,0,1]
    v_pk_fma_f32 v[4:5], v[4:5], s[74:75], s[74:75] op_sel:[0,0,1] op_sel_hi:[1,0,1]
    v_pk_fma_f32 v[6:7], v[6:7], s[74:75], s[74:75] op_sel:[0,0,1] op_sel_hi:[1,0,1]
    v_pk_fma_f32 v[8:9], v[8:9], s[74:75], s[74:75] op_sel:[0,0,1] op_sel_hi:[1,0,1]
    v_cvt_pk_bf16_f32 v24, v2, v3
    v_cvt_pk_bf16_f32 v25, v4, v5
    v_cvt_pk_bf16_f32 v26, v6, v7
    v_cvt_pk_bf16_f32 v27, v8, v9
    buffer_store_dwordx4 v[24:27], v0, s[20:23], s35 offen offset:2048
    v_lshlrev_b32 v2, 16, v28
    v_and_b32 v3, s38, v28
    v_lshlrev_b32 v4, 16, v29
    v_and_b32 v5, s38, v29
    v_lshlrev_b32 v6, 16, v30
    v_and_b32 v7, s38, v30
    v_lshlrev_b32 v8, 16, v31
    v_and_b32 v9, s38, v31
    v_pk_fma_f32 v[2:3], v[2:3], s[74:75], s[74:75] op_sel:[0,0,1] op_sel_hi:[1,0,1]
    v_pk_fma_f32 v[4:5], v[4:5], s[74:75], s[74:75] op_sel:[0,0,1] op_sel_hi:[1,0,1]
    v_pk_fma_f32 v[6:7], v[6:7], s[74:75], s[74:75] op_sel:[0,0,1] op_sel_hi:[1,0,1]
    v_pk_fma_f32 v[8:9], v[8:9], s[74:75], s[74:75] op_sel:[0,0,1] op_sel_hi:[1,0,1]
    v_cvt_pk_bf16_f32 v28, v2, v3
    v_cvt_pk_bf16_f32 v29, v4, v5
    v_cvt_pk_bf16_f32 v30, v6, v7
    v_cvt_pk_bf16_f32 v31, v8, v9
    buffer_store_dwordx4 v[28:31], v0, s[20:23], s35 offen offset:3072
    s_mov_b64 s[74:75], s[72:73]
    v_lshlrev_b32 v2, 16, v32
    v_and_b32 v3, s38, v32
    v_lshlrev_b32 v4, 16, v33
    v_and_b32 v5, s38, v33
    v_lshlrev_b32 v6, 16, v34
    v_and_b32 v7, s38, v34
    v_lshlrev_b32 v8, 16, v35
    v_and_b32 v9, s38, v35
    v_pk_fma_f32 v[2:3], v[2:3], s[74:75], s[74:75] op_sel:[0,0,1] op_sel_hi:[1,0,1]
    v_pk_fma_f32 v[4:5], v[4:5], s[74:75], s[74:75] op_sel:[0,0,1] op_sel_hi:[1,0,1]
    v_pk_fma_f32 v[6:7], v[6:7], s[74:75], s[74:75] op_sel:[0,0,1] op_sel_hi:[1,0,1]
    v_pk_fma_f32 v[8:9], v[8:9], s[74:75], s[74:75] op_sel:[0,0,1] op_sel_hi:[1,0,1]
    v_cvt_pk_bf16_f32 v32, v2, v3
    v_cvt_pk_bf16_f32 v33, v4, v5
    v_cvt_pk_bf16_f32 v34, v6, v7
    v_cvt_pk_bf16_f32 v35, v8, v9
    buffer_store_dwordx4 v[32:35], v0, s[20:23], s36 offen
    v_lshlrev_b32 v2, 16, v36
    v_and_b32 v3, s38, v36
    v_lshlrev_b32 v4, 16, v37
    v_and_b32 v5, s38, v37
    v_lshlrev_b32 v6, 16, v38
    v_and_b32 v7, s38, v38
    v_lshlrev_b32 v8, 16, v39
    v_and_b32 v9, s38, v39
    v_pk_fma_f32 v[2:3], v[2:3], s[74:75], s[74:75] op_sel:[0,0,1] op_sel_hi:[1,0,1]
    v_pk_fma_f32 v[4:5], v[4:5], s[74:75], s[74:75] op_sel:[0,0,1] op_sel_hi:[1,0,1]
    v_pk_fma_f32 v[6:7], v[6:7], s[74:75], s[74:75] op_sel:[0,0,1] op_sel_hi:[1,0,1]
    v_pk_fma_f32 v[8:9], v[8:9], s[74:75], s[74:75] op_sel:[0,0,1] op_sel_hi:[1,0,1]
    v_cvt_pk_bf16_f32 v36, v2, v3
    v_cvt_pk_bf16_f32 v37, v4, v5
    v_cvt_pk_bf16_f32 v38, v6, v7
    v_cvt_pk_bf16_f32 v39, v8, v9
    buffer_store_dwordx4 v[36:39], v0, s[20:23], s36 offen offset:1024
    v_lshlrev_b32 v2, 16, v40
    v_and_b32 v3, s38, v40
    v_lshlrev_b32 v4, 16, v41
    v_and_b32 v5, s38, v41
    v_lshlrev_b32 v6, 16, v42
    v_and_b32 v7, s38, v42
    v_lshlrev_b32 v8, 16, v43
    v_and_b32 v9, s38, v43
    v_pk_fma_f32 v[2:3], v[2:3], s[74:75], s[74:75] op_sel:[0,0,1] op_sel_hi:[1,0,1]
    v_pk_fma_f32 v[4:5], v[4:5], s[74:75], s[74:75] op_sel:[0,0,1] op_sel_hi:[1,0,1]
    v_pk_fma_f32 v[6:7], v[6:7], s[74:75], s[74:75] op_sel:[0,0,1] op_sel_hi:[1,0,1]
    v_pk_fma_f32 v[8:9], v[8:9], s[74:75], s[74:75] op_sel:[0,0,1] op_sel_hi:[1,0,1]
    v_cvt_pk_bf16_f32 v40, v2, v3
    v_cvt_pk_bf16_f32 v41, v4, v5
    v_cvt_pk_bf16_f32 v42, v6, v7
    v_cvt_pk_bf16_f32 v43, v8, v9
    buffer_store_dwordx4 v[40:43], v0, s[20:23], s36 offen offset:2048
    v_lshlrev_b32 v2, 16, v44
    v_and_b32 v3, s38, v44
    v_lshlrev_b32 v4, 16, v45
    v_and_b32 v5, s38, v45
    v_lshlrev_b32 v6, 16, v46
    v_and_b32 v7, s38, v46
    v_lshlrev_b32 v8, 16, v47
    v_and_b32 v9, s38, v47
    v_pk_fma_f32 v[2:3], v[2:3], s[74:75], s[74:75] op_sel:[0,0,1] op_sel_hi:[1,0,1]
    v_pk_fma_f32 v[4:5], v[4:5], s[74:75], s[74:75] op_sel:[0,0,1] op_sel_hi:[1,0,1]
    v_pk_fma_f32 v[6:7], v[6:7], s[74:75], s[74:75] op_sel:[0,0,1] op_sel_hi:[1,0,1]
    v_pk_fma_f32 v[8:9], v[8:9], s[74:75], s[74:75] op_sel:[0,0,1] op_sel_hi:[1,0,1]
    v_cvt_pk_bf16_f32 v44, v2, v3
    v_cvt_pk_bf16_f32 v45, v4, v5
    v_cvt_pk_bf16_f32 v46, v6, v7
    v_cvt_pk_bf16_f32 v47, v8, v9
    buffer_store_dwordx4 v[44:47], v0, s[20:23], s36 offen offset:3072
L_end:
    s_endpgm
.section .rodata,"a"
.p2align 6
.amdhsa_kernel standalone__groupnorm__prompt_kernel
  .amdhsa_next_free_vgpr 128
  .amdhsa_next_free_sgpr 82
  .amdhsa_accum_offset 128
  .amdhsa_group_segment_fixed_size 0
  .amdhsa_kernarg_size 48
  .amdhsa_user_sgpr_count 2
  .amdhsa_user_sgpr_kernarg_segment_ptr 1
  .amdhsa_system_sgpr_workgroup_id_x 1
  .amdhsa_float_denorm_mode_32 3
.end_amdhsa_kernel
```
